```python
import torch

def _softmax(x, axis=-1):
    return torch.softmax(x, dim=axis)
def _gelu(x):
    return torch.nn.functional.gelu(x, approximate="tanh")
def _silu(x):
    return torch.nn.functional.silu(x)
def _sigmoid(x):
    return torch.sigmoid(x)
def _layernorm(x, axis=-1, eps=1e-5):
    m = x.mean(dim=axis, keepdim=True)
    v = x.var(dim=axis, keepdim=True, unbiased=False)
    return (x - m) / torch.sqrt(v + eps)
def _scatter_add(tgt, idx, src, axis=0):
    return tgt.clone().index_add_(axis, idx, src)
def _segment_sum(src, seg, n):
    out = torch.zeros((n,) + src.shape[1:], dtype=src.dtype)
    return out.index_add_(0, seg, src)
def _pad(x, pw):
    flat = tuple(v for pair in reversed(pw) for v in pair)
    return torch.nn.functional.pad(x, flat)

kernel_name = 'parallel_sum__softmax_full_mha__glu_gated_reglu__prompt'

def setup_inputs():

    _w = (lambda a: (lambda t: t.to(torch.bfloat16) if t.is_floating_point() else t)(torch.as_tensor(a)))
    def _A_setup():
        B, S, D = 1, 2048, 512
        return {
            "x": _w((lambda *s: torch.randn(*s, dtype=torch.bfloat16) * 0.05)(B, S, D)),
            "wqkv": _w((lambda *s: torch.randn(*s, dtype=torch.bfloat16) * 0.05)(D, 3 * D)),
            "wo": _w((lambda *s: torch.randn(*s, dtype=torch.bfloat16) * 0.05)(D, D)),
        }
    _A_in = _A_setup()

    def _B_setup():
        B, S, D, F = 1, 2048, 512, 1376
        return {
            "x": _w((lambda *s: torch.randn(*s, dtype=torch.bfloat16) * 0.05)(B, S, D)),
            "W_gate": _w((lambda *s: torch.randn(*s, dtype=torch.bfloat16) * 0.4)(D, F) * (2.0 / D) ** 0.5),
            "W_up": _w((lambda *s: torch.randn(*s, dtype=torch.bfloat16) * 0.4)(D, F) * (2.0 / D) ** 0.5),
            "W_down": _w((lambda *s: torch.randn(*s, dtype=torch.bfloat16) * 0.4)(F, D) * (1.0 / F) ** 0.5),
        }
    _B_in = _B_setup()

    return {
        "A_x": _A_in["x"],
        "A_wqkv": _A_in["wqkv"],
        "A_wo": _A_in["wo"],
        "B_x": _B_in["x"],
        "B_W_gate": _B_in["W_gate"],
        "B_W_up": _B_in["W_up"],
        "B_W_down": _B_in["W_down"],
    }

def reference(A_x, A_wqkv, A_wo, B_x, B_W_gate, B_W_up, B_W_down):
    def _A_ref(x, wqkv, wo):
        B, S, D = x.shape
        H = 32; Dh = D // H
        qkv = (lambda x, *d: x.permute(*d))((x @ wqkv).reshape(B, S, 3, H, Dh), 2, 0, 3, 1, 4)
        q, k, v = qkv[0], qkv[1], qkv[2]
        scale = Dh ** -0.5
        scores = torch.einsum("bhqd,bhkd->bhqk", q, k) * scale
        p = _softmax(scores, axis=-1)
        o = torch.einsum("bhqk,bhkd->bhqd", p, v)
        return (lambda x, *d: x.permute(*d))(o, 0, 2, 1, 3).reshape(B, S, D) @ wo

    def _B_ref(x, W_gate, W_up, W_down):
        gate = torch.einsum("bsd,df->bsf", x, W_gate)
        up = torch.einsum("bsd,df->bsf", x, W_up)
        gate = gate * (lambda x, dt: x.to(dt))(gate > 0, gate.dtype)
        h = gate * up
        return torch.einsum("bsf,fd->bsd", h, W_down)

    x = A_x
    xn = _layernorm(x, axis=-1)
    return x + _A_ref(xn, A_wqkv, A_wo) + _B_ref(xn, B_W_gate, B_W_up, B_W_down)
```

```asm
; @launch grid=(256,1,1) block=(512,1,1) lds=163840
.amdgcn_target "amdgcn-amd-amdhsa--gfx950"
.text
.globl parallel_sum__softmax_full_mha__glu_gated_reglu__prompt_kernel
.p2align 8
.type parallel_sum__softmax_full_mha__glu_gated_reglu__prompt_kernel,@function
parallel_sum__softmax_full_mha__glu_gated_reglu__prompt_kernel:
    s_load_dwordx16 s[4:19], s[0:1], 0
    s_load_dwordx4 s[20:23], s[0:1], 64
    s_cmp_ge_u32 s2, 256
    s_cbranch_scc1 fz_exit
    v_lshrrev_b32 v2, 6, v0
    v_and_b32 v1, 63, v0
    v_readfirstlane_b32 s51, v2
    s_and_b32 s44, s2, 3
    s_lshl_b32 s44, s44, 2
    s_bfe_u32 s47, s2, 0x20003
    s_add_u32 s44, s44, s47
    s_bfe_u32 s45, s2, 0x10002
    s_lshl_b32 s45, s45, 3
    s_lshr_b32 s47, s2, 5
    s_add_u32 s45, s45, s47
    s_lshl_b32 s46, s44, 1
    s_add_u32 s46, s46, s45
    s_and_b32 s3, s51, 3
    s_lshl_b32 s50, s51, 14
    s_lshl_b32 s52, s44, 4
    s_add_u32 s52, s52, s45
    s_lshl_b32 s52, s52, 7
    s_add_u32 s52, s52, 20971520
    s_lshl_b32 s48, s44, 2
    s_add_u32 s48, s48, s3
    s_lshl_b32 s48, s48, 15
    s_mov_b32 s49, 0x3f803f80
    s_cmp_ge_u32 s51, 4
    s_cbranch_scc1 fz_role_b
    s_setprio 0
    s_add_u32 s47, s46, 0
    s_and_b32 s47, s47, 7
    s_lshl_b32 s47, s47, 7
    s_add_u32 s54, s48, s47
    s_add_u32 s47, s46, 1
    s_and_b32 s47, s47, 7
    s_lshl_b32 s47, s47, 7
    s_add_u32 s55, s48, s47
    s_add_u32 s47, s46, 2
    s_and_b32 s47, s47, 7
    s_lshl_b32 s47, s47, 7
    s_add_u32 s56, s48, s47
    s_add_u32 s47, s46, 3
    s_and_b32 s47, s47, 7
    s_lshl_b32 s47, s47, 7
    s_add_u32 s57, s48, s47
    v_lshrrev_b32 v2, 4, v1
    v_and_b32 v3, 7, v1
    v_xor_b32 v2, v2, v3
    v_lshlrev_b32 v2, 4, v2
    v_lshrrev_b32 v3, 3, v1
    v_lshl_add_u32 v5, v3, 10, v2
    v_xor_b32 v6, 64, v5
    v_add_u32 v7, 14336, v5
    v_add_u32 v8, 21504, v6
    v_add_u32 v6, 7168, v6
    s_cmp_eq_u32 s3, 0
    s_cselect_b32 s47, 0, 0x7fff0000
    v_lshlrev_b32 v24, 4, v1
    v_add_u32 v28, s47, v24
    v_mov_b32 v29, 1
    v_mov_b32 v32, 0
    v_mov_b32 v33, 0
    v_mov_b32 v34, 0
    v_mov_b32 v35, 0
    s_waitcnt lgkmcnt(0)
    s_mov_b32 s28, s22
    s_mov_b32 s29, s23
    s_mov_b32 s30, 33554432
    s_mov_b32 s31, 0x20000
    s_mov_b32 s24, s4
    s_mov_b32 s25, s5
    s_mov_b32 s26, 2097152
    s_mov_b32 s27, 0x20000
    s_mov_b64 exec, 0xff
    buffer_store_dwordx4 v[32:35], v28, s[28:31], s52 offen sc1
    s_mov_b64 exec, -1
    s_add_u32 m0, s50, 0
    s_nop 0
    buffer_load_dwordx4 v5, s[24:27], s54 offen offset:0 lds
    buffer_load_dwordx4 v6, s[24:27], s54 offen offset:1024 lds
    buffer_load_dwordx4 v7, s[24:27], s54 offen offset:2048 lds
    buffer_load_dwordx4 v8, s[24:27], s54 offen offset:3072 lds
    s_add_u32 m0, s50, 4096
    s_nop 0
    buffer_load_dwordx4 v5, s[24:27], s55 offen offset:0 lds
    buffer_load_dwordx4 v6, s[24:27], s55 offen offset:1024 lds
    buffer_load_dwordx4 v7, s[24:27], s55 offen offset:2048 lds
    buffer_load_dwordx4 v8, s[24:27], s55 offen offset:3072 lds
    s_mov_b32 s32, s6
    s_mov_b32 s33, s7
    s_mov_b32 s34, 1572864
    s_mov_b32 s35, 0x20000
    s_mov_b32 s36, s20
    s_mov_b32 s37, s21
    s_mov_b32 s38, 256
    s_mov_b32 s39, 0x20000
    s_add_u32 s47, s46, 0
    s_and_b32 s47, s47, 7
    s_mul_i32 s58, s47, 196608
    s_add_u32 s47, s46, 1
    s_and_b32 s47, s47, 7
    s_mul_i32 s59, s47, 196608
    s_add_u32 s47, s46, 2
    s_and_b32 s47, s47, 7
    s_mul_i32 s60, s47, 196608
    s_add_u32 s47, s46, 3
    s_and_b32 s47, s47, 7
    s_mul_i32 s61, s47, 196608
    s_add_u32 s47, s46, 4
    s_and_b32 s47, s47, 7
    s_mul_i32 s62, s47, 196608
    s_add_u32 s47, s46, 5
    s_and_b32 s47, s47, 7
    s_mul_i32 s63, s47, 196608
    s_add_u32 s47, s46, 6
    s_and_b32 s47, s47, 7
    s_mul_i32 s64, s47, 196608
    s_add_u32 s47, s46, 7
    s_and_b32 s47, s47, 7
    s_mul_i32 s65, s47, 196608
    s_lshl_b32 s47, s3, 4
    v_lshrrev_b32 v2, 2, v1
    v_add_u32 v2, s47, v2
    v_mul_u32_u24 v2, 3072, v2
    v_and_b32 v3, 3, v1
    v_lshl_add_u32 v2, v3, 4, v2
    s_lshl_b32 s47, s45, 6
    v_add_u32 v9, s47, v2
    v_add_u32 v10, 1024, v9
    s_lshl_b32 s66, s3, 11
    s_add_u32 s66, s66, 131072
    v_and_b32 v2, 31, v1
    v_lshrrev_b32 v3, 5, v1
    v_bfe_u32 v4, v1, 1, 3
    v_xor_b32 v3, v3, v4
    v_lshlrev_b32 v3, 4, v3
    v_lshl_add_u32 v2, v2, 7, v3
    v_add_u32 v11, s50, v2
    v_xor_b32 v12, 32, v11
    v_xor_b32 v13, 64, v11
    v_xor_b32 v14, 96, v11
    v_lshrrev_b32 v2, 5, v1
    v_lshlrev_b32 v2, 9, v2
    v_bfe_u32 v3, v1, 2, 2
    v_lshl_add_u32 v2, v3, 6, v2
    v_bfe_u32 v3, v1, 4, 1
    v_lshl_add_u32 v2, v3, 5, v2
    v_and_b32 v3, 3, v1
    v_lshl_add_u32 v15, v3, 3, v2
    v_add_u32 v16, 131072, v15
    s_add_u32 s47, s50, 65536
    v_add_u32 v25, s47, v24
    v_mov_b32 v18, 0
    v_mov_b32 v19, 0
    v_mov_b32 v20, 0
    v_mov_b32 v21, 0
    s_lshl_b32 s47, s3, 10
    s_add_u32 s47, s47, 155904
    v_lshl_add_u32 v23, v1, 3, s47
    v_and_b32 v2, 1, v1
    v_lshlrev_b32 v2, 4, v2
    v_mov_b32 v3, 0x3f80
    v_lshlrev_b32 v2, v2, v3
    v_and_b32 v3, 2, v1
    v_cmp_eq_u32 vcc, 0, v3
    s_nop 1
    v_cndmask_b32 v120, 0, v2, vcc
    v_sub_u32 v121, v2, v120
    s_waitcnt vmcnt(4)
    s_add_u32 m0, s50, 8192
    s_nop 0
    buffer_load_dwordx4 v5, s[24:27], s56 offen offset:0 lds
    buffer_load_dwordx4 v6, s[24:27], s56 offen offset:1024 lds
    buffer_load_dwordx4 v7, s[24:27], s56 offen offset:2048 lds
    buffer_load_dwordx4 v8, s[24:27], s56 offen offset:3072 lds
    ds_read_b128 v[128:131], v11 offset:0
    ds_read_b128 v[132:135], v12 offset:0
    ds_read_b128 v[136:139], v13 offset:0
    ds_read_b128 v[140:143], v14 offset:0
    s_waitcnt lgkmcnt(0)
    s_waitcnt vmcnt(4)
    s_add_u32 m0, s50, 12288
    s_nop 0
    buffer_load_dwordx4 v5, s[24:27], s57 offen offset:0 lds
    buffer_load_dwordx4 v6, s[24:27], s57 offen offset:1024 lds
    buffer_load_dwordx4 v7, s[24:27], s57 offen offset:2048 lds
    buffer_load_dwordx4 v8, s[24:27], s57 offen offset:3072 lds
    ds_read_b128 v[144:147], v11 offset:4096
    ds_read_b128 v[148:151], v12 offset:4096
    ds_read_b128 v[152:155], v13 offset:4096
    ds_read_b128 v[156:159], v14 offset:4096
    v_dot2_f32_bf16 v18, v128, s49, v18
    v_dot2_f32_bf16 v19, v128, v128, v19
    v_dot2_f32_bf16 v20, v129, s49, v20
    v_dot2_f32_bf16 v21, v129, v129, v21
    v_dot2_f32_bf16 v18, v130, s49, v18
    v_dot2_f32_bf16 v19, v130, v130, v19
    v_dot2_f32_bf16 v20, v131, s49, v20
    v_dot2_f32_bf16 v21, v131, v131, v21
    v_dot2_f32_bf16 v18, v132, s49, v18
    v_dot2_f32_bf16 v19, v132, v132, v19
    v_dot2_f32_bf16 v20, v133, s49, v20
    v_dot2_f32_bf16 v21, v133, v133, v21
    v_dot2_f32_bf16 v18, v134, s49, v18
    v_dot2_f32_bf16 v19, v134, v134, v19
    v_dot2_f32_bf16 v20, v135, s49, v20
    v_dot2_f32_bf16 v21, v135, v135, v21
    v_dot2_f32_bf16 v18, v136, s49, v18
    v_dot2_f32_bf16 v19, v136, v136, v19
    v_dot2_f32_bf16 v20, v137, s49, v20
    v_dot2_f32_bf16 v21, v137, v137, v21
    v_dot2_f32_bf16 v18, v138, s49, v18
    v_dot2_f32_bf16 v19, v138, v138, v19
    v_dot2_f32_bf16 v20, v139, s49, v20
    v_dot2_f32_bf16 v21, v139, v139, v21
    v_dot2_f32_bf16 v18, v140, s49, v18
    v_dot2_f32_bf16 v19, v140, v140, v19
    v_dot2_f32_bf16 v20, v141, s49, v20
    v_dot2_f32_bf16 v21, v141, v141, v21
    v_dot2_f32_bf16 v18, v142, s49, v18
    v_dot2_f32_bf16 v19, v142, v142, v19
    v_dot2_f32_bf16 v20, v143, s49, v20
    v_dot2_f32_bf16 v21, v143, v143, v21
    s_waitcnt lgkmcnt(0)
    s_waitcnt vmcnt(4)
    ds_read_b128 v[160:163], v11 offset:8192
    ds_read_b128 v[164:167], v12 offset:8192
    ds_read_b128 v[168:171], v13 offset:8192
    ds_read_b128 v[172:175], v14 offset:8192
    v_dot2_f32_bf16 v18, v144, s49, v18
    v_dot2_f32_bf16 v19, v144, v144, v19
    v_dot2_f32_bf16 v20, v145, s49, v20
    v_dot2_f32_bf16 v21, v145, v145, v21
    v_dot2_f32_bf16 v18, v146, s49, v18
    v_dot2_f32_bf16 v19, v146, v146, v19
    v_dot2_f32_bf16 v20, v147, s49, v20
    v_dot2_f32_bf16 v21, v147, v147, v21
    v_dot2_f32_bf16 v18, v148, s49, v18
    v_dot2_f32_bf16 v19, v148, v148, v19
    v_dot2_f32_bf16 v20, v149, s49, v20
    v_dot2_f32_bf16 v21, v149, v149, v21
    v_dot2_f32_bf16 v18, v150, s49, v18
    v_dot2_f32_bf16 v19, v150, v150, v19
    v_dot2_f32_bf16 v20, v151, s49, v20
    v_dot2_f32_bf16 v21, v151, v151, v21
    v_dot2_f32_bf16 v18, v152, s49, v18
    v_dot2_f32_bf16 v19, v152, v152, v19
    v_dot2_f32_bf16 v20, v153, s49, v20
    v_dot2_f32_bf16 v21, v153, v153, v21
    v_dot2_f32_bf16 v18, v154, s49, v18
    v_dot2_f32_bf16 v19, v154, v154, v19
    v_dot2_f32_bf16 v20, v155, s49, v20
    v_dot2_f32_bf16 v21, v155, v155, v21
    v_dot2_f32_bf16 v18, v156, s49, v18
    v_dot2_f32_bf16 v19, v156, v156, v19
    v_dot2_f32_bf16 v20, v157, s49, v20
    v_dot2_f32_bf16 v21, v157, v157, v21
    v_dot2_f32_bf16 v18, v158, s49, v18
    v_dot2_f32_bf16 v19, v158, v158, v19
    v_dot2_f32_bf16 v20, v159, s49, v20
    v_dot2_f32_bf16 v21, v159, v159, v21
    s_waitcnt lgkmcnt(0)
    s_waitcnt vmcnt(0)
    ds_read_b128 v[176:179], v11 offset:12288
    ds_read_b128 v[180:183], v12 offset:12288
    ds_read_b128 v[184:187], v13 offset:12288
    ds_read_b128 v[188:191], v14 offset:12288
    v_dot2_f32_bf16 v18, v160, s49, v18
    v_dot2_f32_bf16 v19, v160, v160, v19
    v_dot2_f32_bf16 v20, v161, s49, v20
    v_dot2_f32_bf16 v21, v161, v161, v21
    v_dot2_f32_bf16 v18, v162, s49, v18
    v_dot2_f32_bf16 v19, v162, v162, v19
    v_dot2_f32_bf16 v20, v163, s49, v20
    v_dot2_f32_bf16 v21, v163, v163, v21
    v_dot2_f32_bf16 v18, v164, s49, v18
    v_dot2_f32_bf16 v19, v164, v164, v19
    v_dot2_f32_bf16 v20, v165, s49, v20
    v_dot2_f32_bf16 v21, v165, v165, v21
    v_dot2_f32_bf16 v18, v166, s49, v18
    v_dot2_f32_bf16 v19, v166, v166, v19
    v_dot2_f32_bf16 v20, v167, s49, v20
    v_dot2_f32_bf16 v21, v167, v167, v21
    v_dot2_f32_bf16 v18, v168, s49, v18
    v_dot2_f32_bf16 v19, v168, v168, v19
    v_dot2_f32_bf16 v20, v169, s49, v20
    v_dot2_f32_bf16 v21, v169, v169, v21
    v_dot2_f32_bf16 v18, v170, s49, v18
    v_dot2_f32_bf16 v19, v170, v170, v19
    v_dot2_f32_bf16 v20, v171, s49, v20
    v_dot2_f32_bf16 v21, v171, v171, v21
    v_dot2_f32_bf16 v18, v172, s49, v18
    v_dot2_f32_bf16 v19, v172, v172, v19
    v_dot2_f32_bf16 v20, v173, s49, v20
    v_dot2_f32_bf16 v21, v173, v173, v21
    v_dot2_f32_bf16 v18, v174, s49, v18
    v_dot2_f32_bf16 v19, v174, v174, v19
    v_dot2_f32_bf16 v20, v175, s49, v20
    v_dot2_f32_bf16 v21, v175, v175, v21
    s_waitcnt lgkmcnt(0)
    v_dot2_f32_bf16 v18, v176, s49, v18
    v_dot2_f32_bf16 v19, v176, v176, v19
    v_dot2_f32_bf16 v20, v177, s49, v20
    v_dot2_f32_bf16 v21, v177, v177, v21
    v_dot2_f32_bf16 v18, v178, s49, v18
    v_dot2_f32_bf16 v19, v178, v178, v19
    v_dot2_f32_bf16 v20, v179, s49, v20
    v_dot2_f32_bf16 v21, v179, v179, v21
    v_dot2_f32_bf16 v18, v180, s49, v18
    v_dot2_f32_bf16 v19, v180, v180, v19
    v_dot2_f32_bf16 v20, v181, s49, v20
    v_dot2_f32_bf16 v21, v181, v181, v21
    v_dot2_f32_bf16 v18, v182, s49, v18
    v_dot2_f32_bf16 v19, v182, v182, v19
    v_dot2_f32_bf16 v20, v183, s49, v20
    v_dot2_f32_bf16 v21, v183, v183, v21
    v_dot2_f32_bf16 v18, v184, s49, v18
    v_dot2_f32_bf16 v19, v184, v184, v19
    v_dot2_f32_bf16 v20, v185, s49, v20
    v_dot2_f32_bf16 v21, v185, v185, v21
    v_dot2_f32_bf16 v18, v186, s49, v18
    v_dot2_f32_bf16 v19, v186, v186, v19
    v_dot2_f32_bf16 v20, v187, s49, v20
    v_dot2_f32_bf16 v21, v187, v187, v21
    v_dot2_f32_bf16 v18, v188, s49, v18
    v_dot2_f32_bf16 v19, v188, v188, v19
    v_dot2_f32_bf16 v20, v189, s49, v20
    v_dot2_f32_bf16 v21, v189, v189, v21
    v_dot2_f32_bf16 v18, v190, s49, v18
    v_dot2_f32_bf16 v19, v190, v190, v19
    v_dot2_f32_bf16 v20, v191, s49, v20
    v_dot2_f32_bf16 v21, v191, v191, v21
    s_nop 1
    v_add_f32 v18, v18, v20
    v_add_f32 v19, v19, v21
    ds_write_b64 v23, v[18:19] offset:0
    s_lshl_b32 s47, s45, 4
    s_mov_b64 exec, 1
    buffer_atomic_add v29, v28, s[36:39], s47 offen sc1
    s_mov_b64 exec, -1
    s_add_u32 m0, s66, 0
    s_nop 0
    buffer_load_dwordx4 v10, s[32:35], s58 offen offset:0 lds
    buffer_load_dwordx4 v10, s[32:35], s58 offen offset:1024 lds
    s_add_u32 m0, s66, 8192
    s_nop 0
    buffer_load_dwordx4 v10, s[32:35], s59 offen offset:0 lds
    buffer_load_dwordx4 v10, s[32:35], s59 offen offset:1024 lds
    s_add_u32 m0, s66, 16384
    s_nop 0
    buffer_load_dwordx4 v10, s[32:35], s60 offen offset:0 lds
    buffer_load_dwordx4 v10, s[32:35], s60 offen offset:1024 lds
    s_waitcnt lgkmcnt(0)
    s_barrier
    ds_read_b64 v[20:21], v23 offset:512
    s_setprio 2
    s_waitcnt lgkmcnt(0)
    v_add_f32 v18, v18, v20
    v_add_f32 v20, v19, v21
    v_mov_b32 v19, v18
    v_mov_b32 v21, v20
    s_nop 0
    v_permlane32_swap_b32 v18, v19
    v_permlane32_swap_b32 v20, v21
    v_add_f32 v18, v18, v19
    v_add_f32 v20, v20, v21
    v_mul_f32 v116, 0xbb000000, v18
    v_mul_f32 v117, 0xbb000000, v18
    v_mul_f32 v118, 0xbb000000, v18
    v_mul_f32 v119, 0xbb000000, v18
    s_nop 1
    v_mfma_f32_4x4x4_16b_bf16 v[100:103], v[120:121], v[128:129], v[116:119]
    v_mfma_f32_4x4x4_16b_bf16 v[104:107], v[120:121], v[130:131], v[116:119]
    v_mul_f32 v20, 0x3b000000, v20
    v_fma_f32 v20, -v116, v116, v20
    v_max_f32 v20, 0, v20
    v_add_f32 v20, 0x3727c5ac, v20
    v_rsq_f32 v22, v20
    s_lshl_b32 s47, s3, 7
    s_add_u32 s47, s47, 160512
    v_and_b32 v2, 31, v1
    v_lshl_add_u32 v2, v2, 2, s47
    v_lshrrev_b32 v3, 5, v1
    v_lshl_add_u32 v23, v3, 4, s47
    ds_write_b32 v2, v22
    v_mfma_f32_4x4x4_16b_bf16 v[108:111], v[120:121], v[132:133], v[116:119]
    v_mfma_f32_4x4x4_16b_bf16 v[112:115], v[120:121], v[134:135], v[116:119]
    v_cvt_pk_bf16_f32 v128, v100, v101
    v_cvt_pk_bf16_f32 v129, v102, v103
    v_cvt_pk_bf16_f32 v130, v104, v105
    v_cvt_pk_bf16_f32 v131, v106, v107
    s_barrier
    s_add_u32 m0, s50, 0
    s_nop 0
    buffer_load_dwordx4 v10, s[32:35], s61 offen offset:0 lds
    buffer_load_dwordx4 v10, s[32:35], s61 offen offset:1024 lds
    v_mfma_f32_4x4x4_16b_bf16 v[100:103], v[120:121], v[136:137], v[116:119]
    v_mfma_f32_4x4x4_16b_bf16 v[104:107], v[120:121], v[138:139], v[116:119]
    v_cvt_pk_bf16_f32 v132, v108, v109
    v_cvt_pk_bf16_f32 v133, v110, v111
    v_cvt_pk_bf16_f32 v134, v112, v113
    v_cvt_pk_bf16_f32 v135, v114, v115
    s_add_u32 m0, s50, 2048
    s_nop 0
    buffer_load_dwordx4 v10, s[32:35], s62 offen offset:0 lds
    buffer_load_dwordx4 v10, s[32:35], s62 offen offset:1024 lds
    v_mfma_f32_4x4x4_16b_bf16 v[108:111], v[120:121], v[140:141], v[116:119]
    v_mfma_f32_4x4x4_16b_bf16 v[112:115], v[120:121], v[142:143], v[116:119]
    v_cvt_pk_bf16_f32 v136, v100, v101
    v_cvt_pk_bf16_f32 v137, v102, v103
    v_cvt_pk_bf16_f32 v138, v104, v105
    v_cvt_pk_bf16_f32 v139, v106, v107
    s_add_u32 m0, s50, 4096
    s_nop 0
    buffer_load_dwordx4 v10, s[32:35], s63 offen offset:0 lds
    buffer_load_dwordx4 v10, s[32:35], s63 offen offset:1024 lds
    v_mfma_f32_4x4x4_16b_bf16 v[100:103], v[120:121], v[144:145], v[116:119]
    v_mfma_f32_4x4x4_16b_bf16 v[104:107], v[120:121], v[146:147], v[116:119]
    v_cvt_pk_bf16_f32 v140, v108, v109
    v_cvt_pk_bf16_f32 v141, v110, v111
    v_cvt_pk_bf16_f32 v142, v112, v113
    v_cvt_pk_bf16_f32 v143, v114, v115
    s_add_u32 m0, s50, 6144
    s_nop 0
    buffer_load_dwordx4 v10, s[32:35], s64 offen offset:0 lds
    buffer_load_dwordx4 v10, s[32:35], s64 offen offset:1024 lds
    s_waitcnt vmcnt(10)
    s_barrier
    ds_read_b64_tr_b16 v[36:37], v16 offset:0
    ds_read_b64_tr_b16 v[38:39], v16 offset:256
    ds_read_b64_tr_b16 v[40:41], v16 offset:1024
    ds_read_b64_tr_b16 v[42:43], v16 offset:1280
    ds_read_b64_tr_b16 v[44:45], v16 offset:2048
    ds_read_b64_tr_b16 v[46:47], v16 offset:2304
    ds_read_b64_tr_b16 v[48:49], v16 offset:3072
    ds_read_b64_tr_b16 v[50:51], v16 offset:3328
    s_waitcnt lgkmcnt(4)
    v_mfma_f32_32x32x16_bf16 v[68:83], v[36:39], v[128:131], 0
    ds_read_b64_tr_b16 v[52:53], v16 offset:4096
    ds_read_b64_tr_b16 v[54:55], v16 offset:4352
    v_cvt_pk_bf16_f32 v144, v100, v101
    v_cvt_pk_bf16_f32 v145, v102, v103
    v_cvt_pk_bf16_f32 v146, v104, v105
    v_cvt_pk_bf16_f32 v147, v106, v107
    v_mfma_f32_32x32x16_bf16 v[84:99], v[128:131], v[40:43], 0
    ds_read_b64_tr_b16 v[56:57], v16 offset:5120
    ds_read_b64_tr_b16 v[58:59], v16 offset:5376
    s_add_u32 m0, s50, 8192
    s_nop 0
    buffer_load_dwordx4 v10, s[32:35], s65 offen offset:0 lds
    buffer_load_dwordx4 v10, s[32:35], s65 offen offset:1024 lds
    v_mfma_f32_4x4x4_16b_bf16 v[108:111], v[120:121], v[148:149], v[116:119]
    v_mfma_f32_4x4x4_16b_bf16 v[112:115], v[120:121], v[150:151], v[116:119]
    s_waitcnt lgkmcnt(4)
    v_mfma_f32_32x32x16_bf16 v[68:83], v[44:47], v[132:135], v[68:83]
    ds_read_b64_tr_b16 v[60:61], v16 offset:6144
    ds_read_b64_tr_b16 v[62:63], v16 offset:6400
    v_cvt_pk_bf16_f32 v148, v108, v109
    v_cvt_pk_bf16_f32 v149, v110, v111
    v_cvt_pk_bf16_f32 v150, v112, v113
    v_cvt_pk_bf16_f32 v151, v114, v115
    v_mfma_f32_32x32x16_bf16 v[84:99], v[132:135], v[48:51], v[84:99]
    ds_read_b64_tr_b16 v[64:65], v16 offset:7168
    ds_read_b64_tr_b16 v[66:67], v16 offset:7424
    s_add_u32 m0, s50, 10240
    s_nop 0
    buffer_load_dwordx4 v9, s[32:35], s58 offen lds
    v_mfma_f32_4x4x4_16b_bf16 v[100:103], v[120:121], v[152:153], v[116:119]
    v_mfma_f32_4x4x4_16b_bf16 v[104:107], v[120:121], v[154:155], v[116:119]
    s_waitcnt lgkmcnt(4)
    v_mfma_f32_32x32x16_bf16 v[68:83], v[52:55], v[136:139], v[68:83]
    ds_read_b64_tr_b16 v[36:37], v16 offset:8192
    ds_read_b64_tr_b16 v[38:39], v16 offset:8448
    v_cvt_pk_bf16_f32 v152, v100, v101
    v_cvt_pk_bf16_f32 v153, v102, v103
    v_cvt_pk_bf16_f32 v154, v104, v105
    v_cvt_pk_bf16_f32 v155, v106, v107
    v_mfma_f32_32x32x16_bf16 v[84:99], v[136:139], v[56:59], v[84:99]
    ds_read_b64_tr_b16 v[40:41], v16 offset:9216
    ds_read_b64_tr_b16 v[42:43], v16 offset:9472
    s_add_u32 m0, s50, 11264
    s_nop 0
    buffer_load_dwordx4 v9, s[32:35], s59 offen lds
    v_mfma_f32_4x4x4_16b_bf16 v[108:111], v[120:121], v[156:157], v[116:119]
    v_mfma_f32_4x4x4_16b_bf16 v[112:115], v[120:121], v[158:159], v[116:119]
    s_waitcnt lgkmcnt(4)
    v_mfma_f32_32x32x16_bf16 v[68:83], v[60:63], v[140:143], v[68:83]
    ds_read_b64_tr_b16 v[44:45], v16 offset:10240
    ds_read_b64_tr_b16 v[46:47], v16 offset:10496
    v_cvt_pk_bf16_f32 v156, v108, v109
    v_cvt_pk_bf16_f32 v157, v110, v111
    v_cvt_pk_bf16_f32 v158, v112, v113
    v_cvt_pk_bf16_f32 v159, v114, v115
    v_mfma_f32_32x32x16_bf16 v[84:99], v[140:143], v[64:67], v[84:99]
    ds_read_b64_tr_b16 v[48:49], v16 offset:11264
    ds_read_b64_tr_b16 v[50:51], v16 offset:11520
    s_add_u32 m0, s50, 12288
    s_nop 0
    buffer_load_dwordx4 v9, s[32:35], s60 offen lds
    v_mfma_f32_4x4x4_16b_bf16 v[100:103], v[120:121], v[160:161], v[116:119]
    v_mfma_f32_4x4x4_16b_bf16 v[104:107], v[120:121], v[162:163], v[116:119]
    s_waitcnt lgkmcnt(4)
    v_mfma_f32_32x32x16_bf16 v[68:83], v[36:39], v[144:147], v[68:83]
    ds_read_b64_tr_b16 v[52:53], v16 offset:12288
    ds_read_b64_tr_b16 v[54:55], v16 offset:12544
    v_cvt_pk_bf16_f32 v160, v100, v101
    v_cvt_pk_bf16_f32 v161, v102, v103
    v_cvt_pk_bf16_f32 v162, v104, v105
    v_cvt_pk_bf16_f32 v163, v106, v107
    v_mfma_f32_32x32x16_bf16 v[84:99], v[144:147], v[40:43], v[84:99]
    ds_read_b64_tr_b16 v[56:57], v16 offset:13312
    ds_read_b64_tr_b16 v[58:59], v16 offset:13568
    s_add_u32 m0, s50, 13312
    s_nop 0
    buffer_load_dwordx4 v9, s[32:35], s61 offen lds
    v_mfma_f32_4x4x4_16b_bf16 v[108:111], v[120:121], v[164:165], v[116:119]
    v_mfma_f32_4x4x4_16b_bf16 v[112:115], v[120:121], v[166:167], v[116:119]
    s_waitcnt lgkmcnt(4)
    v_mfma_f32_32x32x16_bf16 v[68:83], v[44:47], v[148:151], v[68:83]
    ds_read_b64_tr_b16 v[60:61], v16 offset:14336
    ds_read_b64_tr_b16 v[62:63], v16 offset:14592
    v_cvt_pk_bf16_f32 v164, v108, v109
    v_cvt_pk_bf16_f32 v165, v110, v111
    v_cvt_pk_bf16_f32 v166, v112, v113
    v_cvt_pk_bf16_f32 v167, v114, v115
    v_mfma_f32_32x32x16_bf16 v[84:99], v[148:151], v[48:51], v[84:99]
    ds_read_b64_tr_b16 v[64:65], v16 offset:15360
    ds_read_b64_tr_b16 v[66:67], v16 offset:15616
    s_add_u32 m0, s50, 14336
    s_nop 0
    buffer_load_dwordx4 v9, s[32:35], s62 offen lds
    v_mfma_f32_4x4x4_16b_bf16 v[100:103], v[120:121], v[168:169], v[116:119]
    v_mfma_f32_4x4x4_16b_bf16 v[104:107], v[120:121], v[170:171], v[116:119]
    s_waitcnt vmcnt(13)
    s_barrier
    s_waitcnt lgkmcnt(4)
    v_mfma_f32_32x32x16_bf16 v[68:83], v[52:55], v[152:155], v[68:83]
    ds_read_b64_tr_b16 v[36:37], v16 offset:16384
    ds_read_b64_tr_b16 v[38:39], v16 offset:16640
    v_cvt_pk_bf16_f32 v168, v100, v101
    v_cvt_pk_bf16_f32 v169, v102, v103
    v_cvt_pk_bf16_f32 v170, v104, v105
    v_cvt_pk_bf16_f32 v171, v106, v107
    v_mfma_f32_32x32x16_bf16 v[84:99], v[152:155], v[56:59], v[84:99]
    ds_read_b64_tr_b16 v[40:41], v16 offset:17408
    ds_read_b64_tr_b16 v[42:43], v16 offset:17664
    s_add_u32 m0, s50, 15360
    s_nop 0
    buffer_load_dwordx4 v9, s[32:35], s63 offen lds
    v_mfma_f32_4x4x4_16b_bf16 v[108:111], v[120:121], v[172:173], v[116:119]
    v_mfma_f32_4x4x4_16b_bf16 v[112:115], v[120:121], v[174:175], v[116:119]
    s_waitcnt lgkmcnt(4)
    v_mfma_f32_32x32x16_bf16 v[68:83], v[60:63], v[156:159], v[68:83]
    ds_read_b64_tr_b16 v[44:45], v16 offset:18432
    ds_read_b64_tr_b16 v[46:47], v16 offset:18688
    v_cvt_pk_bf16_f32 v172, v108, v109
    v_cvt_pk_bf16_f32 v173, v110, v111
    v_cvt_pk_bf16_f32 v174, v112, v113
    v_cvt_pk_bf16_f32 v175, v114, v115
    v_mfma_f32_32x32x16_bf16 v[84:99], v[156:159], v[64:67], v[84:99]
    ds_read_b64_tr_b16 v[48:49], v16 offset:19456
    ds_read_b64_tr_b16 v[50:51], v16 offset:19712
    v_mfma_f32_4x4x4_16b_bf16 v[100:103], v[120:121], v[176:177], v[116:119]
    v_mfma_f32_4x4x4_16b_bf16 v[104:107], v[120:121], v[178:179], v[116:119]
    s_waitcnt lgkmcnt(4)
    v_mfma_f32_32x32x16_bf16 v[68:83], v[36:39], v[160:163], v[68:83]
    ds_read_b64_tr_b16 v[52:53], v16 offset:20480
    ds_read_b64_tr_b16 v[54:55], v16 offset:20736
    v_cvt_pk_bf16_f32 v176, v100, v101
    v_cvt_pk_bf16_f32 v177, v102, v103
    v_cvt_pk_bf16_f32 v178, v104, v105
    v_cvt_pk_bf16_f32 v179, v106, v107
    v_mfma_f32_32x32x16_bf16 v[84:99], v[160:163], v[40:43], v[84:99]
    ds_read_b64_tr_b16 v[56:57], v16 offset:21504
    ds_read_b64_tr_b16 v[58:59], v16 offset:21760
    v_mfma_f32_4x4x4_16b_bf16 v[108:111], v[120:121], v[180:181], v[116:119]
    v_mfma_f32_4x4x4_16b_bf16 v[112:115], v[120:121], v[182:183], v[116:119]
    s_waitcnt lgkmcnt(4)
    v_mfma_f32_32x32x16_bf16 v[68:83], v[44:47], v[164:167], v[68:83]
    ds_read_b64_tr_b16 v[60:61], v16 offset:22528
    ds_read_b64_tr_b16 v[62:63], v16 offset:22784
    v_cvt_pk_bf16_f32 v180, v108, v109
    v_cvt_pk_bf16_f32 v181, v110, v111
    v_cvt_pk_bf16_f32 v182, v112, v113
    v_cvt_pk_bf16_f32 v183, v114, v115
    v_mfma_f32_32x32x16_bf16 v[84:99], v[164:167], v[48:51], v[84:99]
    ds_read_b64_tr_b16 v[64:65], v16 offset:23552
    ds_read_b64_tr_b16 v[66:67], v16 offset:23808
    v_mfma_f32_4x4x4_16b_bf16 v[100:103], v[120:121], v[184:185], v[116:119]
    v_mfma_f32_4x4x4_16b_bf16 v[104:107], v[120:121], v[186:187], v[116:119]
    s_waitcnt lgkmcnt(4)
    v_mfma_f32_32x32x16_bf16 v[68:83], v[52:55], v[168:171], v[68:83]
    ds_read_b64_tr_b16 v[36:37], v15 offset:0
    ds_read_b64_tr_b16 v[38:39], v15 offset:256
    v_cvt_pk_bf16_f32 v184, v100, v101
    v_cvt_pk_bf16_f32 v185, v102, v103
    v_cvt_pk_bf16_f32 v186, v104, v105
    v_cvt_pk_bf16_f32 v187, v106, v107
    v_mfma_f32_32x32x16_bf16 v[84:99], v[168:171], v[56:59], v[84:99]
    ds_read_b64_tr_b16 v[40:41], v15 offset:1024
    ds_read_b64_tr_b16 v[42:43], v15 offset:1280
    v_mfma_f32_4x4x4_16b_bf16 v[108:111], v[120:121], v[188:189], v[116:119]
    v_mfma_f32_4x4x4_16b_bf16 v[112:115], v[120:121], v[190:191], v[116:119]
    s_waitcnt lgkmcnt(4)
    v_mfma_f32_32x32x16_bf16 v[68:83], v[60:63], v[172:175], v[68:83]
    ds_read_b64_tr_b16 v[44:45], v15 offset:16384
    ds_read_b64_tr_b16 v[46:47], v15 offset:16640
    v_cvt_pk_bf16_f32 v188, v108, v109
    v_cvt_pk_bf16_f32 v189, v110, v111
    v_cvt_pk_bf16_f32 v190, v112, v113
    v_cvt_pk_bf16_f32 v191, v114, v115
    v_mfma_f32_32x32x16_bf16 v[84:99], v[172:175], v[64:67], v[84:99]
    ds_read_b64_tr_b16 v[48:49], v15 offset:17408
    ds_read_b64_tr_b16 v[50:51], v15 offset:17664
    s_waitcnt lgkmcnt(4)
    v_mfma_f32_32x32x16_bf16 v[68:83], v[36:39], v[176:179], v[68:83]
    ds_read_b64_tr_b16 v[52:53], v15 offset:32768
    ds_read_b64_tr_b16 v[54:55], v15 offset:33024
    v_mfma_f32_32x32x16_bf16 v[84:99], v[176:179], v[40:43], v[84:99]
    ds_read_b64_tr_b16 v[56:57], v15 offset:33792
    ds_read_b64_tr_b16 v[58:59], v15 offset:34048
    s_waitcnt lgkmcnt(4)
    v_mfma_f32_32x32x16_bf16 v[68:83], v[44:47], v[180:183], v[68:83]
    ds_read_b64_tr_b16 v[60:61], v15 offset:49152
    ds_read_b64_tr_b16 v[62:63], v15 offset:49408
    v_mfma_f32_32x32x16_bf16 v[84:99], v[180:183], v[48:51], v[84:99]
    ds_read_b64_tr_b16 v[64:65], v15 offset:50176
    ds_read_b64_tr_b16 v[66:67], v15 offset:50432
    s_waitcnt vmcnt(10)
    s_barrier
    s_waitcnt lgkmcnt(4)
    v_mfma_f32_32x32x16_bf16 v[68:83], v[52:55], v[184:187], v[68:83]
    ds_read_b64_tr_b16 v[36:37], v15 offset:2048
    ds_read_b64_tr_b16 v[38:39], v15 offset:2304
    ds_read_b128 v[192:195], v25 offset:0
    v_mfma_f32_32x32x16_bf16 v[84:99], v[184:187], v[56:59], v[84:99]
    ds_read_b64_tr_b16 v[40:41], v15 offset:3072
    ds_read_b64_tr_b16 v[42:43], v15 offset:3328
    s_waitcnt lgkmcnt(5)
    v_mfma_f32_32x32x16_bf16 v[68:83], v[60:63], v[188:191], v[68:83]
    ds_read_b64_tr_b16 v[44:45], v15 offset:18432
    ds_read_b64_tr_b16 v[46:47], v15 offset:18688
    ds_read_b128 v[196:199], v25 offset:1024
    v_mfma_f32_32x32x16_bf16 v[84:99], v[188:191], v[64:67], v[84:99]
    ds_read_b64_tr_b16 v[48:49], v15 offset:19456
    ds_read_b64_tr_b16 v[50:51], v15 offset:19712
    s_waitcnt lgkmcnt(5)
    v_mfma_f32_32x32x16_bf16 v[68:83], v[36:39], v[192:195], v[68:83]
    ds_read_b64_tr_b16 v[52:53], v15 offset:34816
    ds_read_b64_tr_b16 v[54:55], v15 offset:35072
    ds_read_b128 v[200:203], v25 offset:2048
    v_mfma_f32_32x32x16_bf16 v[84:99], v[192:195], v[40:43], v[84:99]
    ds_read_b64_tr_b16 v[56:57], v15 offset:35840
    ds_read_b64_tr_b16 v[58:59], v15 offset:36096
    s_waitcnt lgkmcnt(5)
    v_mfma_f32_32x32x16_bf16 v[68:83], v[44:47], v[196:199], v[68:83]
    ds_read_b64_tr_b16 v[60:61], v15 offset:51200
    ds_read_b64_tr_b16 v[62:63], v15 offset:51456
    ds_read_b128 v[204:207], v25 offset:3072
    v_mfma_f32_32x32x16_bf16 v[84:99], v[196:199], v[48:51], v[84:99]
    ds_read_b64_tr_b16 v[64:65], v15 offset:52224
    ds_read_b64_tr_b16 v[66:67], v15 offset:52480
    s_waitcnt lgkmcnt(5)
    v_mfma_f32_32x32x16_bf16 v[68:83], v[52:55], v[200:203], v[68:83]
    ds_read_b64_tr_b16 v[36:37], v15 offset:4096
    ds_read_b64_tr_b16 v[38:39], v15 offset:4352
    ds_read_b128 v[208:211], v25 offset:4096
    v_mfma_f32_32x32x16_bf16 v[84:99], v[200:203], v[56:59], v[84:99]
    ds_read_b64_tr_b16 v[40:41], v15 offset:5120
    ds_read_b64_tr_b16 v[42:43], v15 offset:5376
    s_waitcnt lgkmcnt(5)
    v_mfma_f32_32x32x16_bf16 v[68:83], v[60:63], v[204:207], v[68:83]
    ds_read_b64_tr_b16 v[44:45], v15 offset:20480
    ds_read_b64_tr_b16 v[46:47], v15 offset:20736
    ds_read_b128 v[212:215], v25 offset:5120
    v_mfma_f32_32x32x16_bf16 v[84:99], v[204:207], v[64:67], v[84:99]
    ds_read_b64_tr_b16 v[48:49], v15 offset:21504
    ds_read_b64_tr_b16 v[50:51], v15 offset:21760
    s_waitcnt lgkmcnt(5)
    v_mfma_f32_32x32x16_bf16 v[68:83], v[36:39], v[208:211], v[68:83]
    ds_read_b64_tr_b16 v[52:53], v15 offset:36864
    ds_read_b64_tr_b16 v[54:55], v15 offset:37120
    ds_read_b128 v[216:219], v25 offset:6144
    v_mfma_f32_32x32x16_bf16 v[84:99], v[208:211], v[40:43], v[84:99]
    ds_read_b64_tr_b16 v[56:57], v15 offset:37888
    ds_read_b64_tr_b16 v[58:59], v15 offset:38144
    s_waitcnt lgkmcnt(5)
    v_mfma_f32_32x32x16_bf16 v[68:83], v[44:47], v[212:215], v[68:83]
    ds_read_b64_tr_b16 v[60:61], v15 offset:53248
    ds_read_b64_tr_b16 v[62:63], v15 offset:53504
    ds_read_b128 v[220:223], v25 offset:7168
    v_mfma_f32_32x32x16_bf16 v[84:99], v[212:215], v[48:51], v[84:99]
    ds_read_b64_tr_b16 v[64:65], v15 offset:54272
    ds_read_b64_tr_b16 v[66:67], v15 offset:54528
    s_waitcnt vmcnt(6)
    s_barrier
    s_add_u32 m0, s50, 0
    s_nop 0
    buffer_load_dwordx4 v9, s[32:35], s64 offen lds
    s_add_u32 m0, s50, 1024
    s_nop 0
    buffer_load_dwordx4 v9, s[32:35], s65 offen lds
    s_waitcnt lgkmcnt(5)
    v_mfma_f32_32x32x16_bf16 v[68:83], v[52:55], v[216:219], v[68:83]
    ds_read_b64_tr_b16 v[36:37], v15 offset:6144
    ds_read_b64_tr_b16 v[38:39], v15 offset:6400
    ds_read_b128 v[224:227], v25 offset:8192
    v_mfma_f32_32x32x16_bf16 v[84:99], v[216:219], v[56:59], v[84:99]
    ds_read_b64_tr_b16 v[40:41], v15 offset:7168
    ds_read_b64_tr_b16 v[42:43], v15 offset:7424
    s_waitcnt lgkmcnt(5)
    v_mfma_f32_32x32x16_bf16 v[68:83], v[60:63], v[220:223], v[68:83]
    ds_read_b64_tr_b16 v[44:45], v15 offset:22528
    ds_read_b64_tr_b16 v[46:47], v15 offset:22784
    ds_read_b128 v[228:231], v25 offset:9216
    v_mfma_f32_32x32x16_bf16 v[84:99], v[220:223], v[64:67], v[84:99]
    ds_read_b64_tr_b16 v[48:49], v15 offset:23552
    ds_read_b64_tr_b16 v[50:51], v15 offset:23808
    s_waitcnt lgkmcnt(5)
    v_mfma_f32_32x32x16_bf16 v[68:83], v[36:39], v[224:227], v[68:83]
    ds_read_b64_tr_b16 v[52:53], v15 offset:38912
    ds_read_b64_tr_b16 v[54:55], v15 offset:39168
    ds_read_b128 v[232:235], v25 offset:10240
    v_mfma_f32_32x32x16_bf16 v[84:99], v[224:227], v[40:43], v[84:99]
    ds_read_b64_tr_b16 v[56:57], v15 offset:39936
    ds_read_b64_tr_b16 v[58:59], v15 offset:40192
    s_waitcnt lgkmcnt(5)
    v_mfma_f32_32x32x16_bf16 v[68:83], v[44:47], v[228:231], v[68:83]
    ds_read_b64_tr_b16 v[60:61], v15 offset:55296
    ds_read_b64_tr_b16 v[62:63], v15 offset:55552
    ds_read_b128 v[236:239], v25 offset:11264
    v_mfma_f32_32x32x16_bf16 v[84:99], v[228:231], v[48:51], v[84:99]
    ds_read_b64_tr_b16 v[64:65], v15 offset:56320
    ds_read_b64_tr_b16 v[66:67], v15 offset:56576
    s_waitcnt lgkmcnt(5)
    v_mfma_f32_32x32x16_bf16 v[68:83], v[52:55], v[232:235], v[68:83]
    ds_read_b64_tr_b16 v[36:37], v15 offset:8192
    ds_read_b64_tr_b16 v[38:39], v15 offset:8448
    ds_read_b128 v[240:243], v25 offset:12288
    v_mfma_f32_32x32x16_bf16 v[84:99], v[232:235], v[56:59], v[84:99]
    ds_read_b64_tr_b16 v[40:41], v15 offset:9216
    ds_read_b64_tr_b16 v[42:43], v15 offset:9472
    s_waitcnt lgkmcnt(5)
    v_mfma_f32_32x32x16_bf16 v[68:83], v[60:63], v[236:239], v[68:83]
    ds_read_b64_tr_b16 v[44:45], v15 offset:24576
    ds_read_b64_tr_b16 v[46:47], v15 offset:24832
    ds_read_b128 v[244:247], v25 offset:13312
    v_mfma_f32_32x32x16_bf16 v[84:99], v[236:239], v[64:67], v[84:99]
    ds_read_b64_tr_b16 v[48:49], v15 offset:25600
    ds_read_b64_tr_b16 v[50:51], v15 offset:25856
    s_waitcnt lgkmcnt(5)
    v_mfma_f32_32x32x16_bf16 v[68:83], v[36:39], v[240:243], v[68:83]
    ds_read_b64_tr_b16 v[52:53], v15 offset:40960
    ds_read_b64_tr_b16 v[54:55], v15 offset:41216
    ds_read_b128 v[248:251], v25 offset:14336
    v_mfma_f32_32x32x16_bf16 v[84:99], v[240:243], v[40:43], v[84:99]
    ds_read_b64_tr_b16 v[56:57], v15 offset:41984
    ds_read_b64_tr_b16 v[58:59], v15 offset:42240
    ds_read_b128 v[100:103], v23 offset:0
    s_waitcnt lgkmcnt(6)
    v_mfma_f32_32x32x16_bf16 v[68:83], v[44:47], v[244:247], v[68:83]
    ds_read_b64_tr_b16 v[60:61], v15 offset:57344
    ds_read_b64_tr_b16 v[62:63], v15 offset:57600
    ds_read_b128 v[252:255], v25 offset:15360
    v_mfma_f32_32x32x16_bf16 v[84:99], v[244:247], v[48:51], v[84:99]
    ds_read_b64_tr_b16 v[64:65], v15 offset:58368
    ds_read_b64_tr_b16 v[66:67], v15 offset:58624
    ds_read_b128 v[104:107], v23 offset:32
    s_waitcnt lgkmcnt(7)
    v_mfma_f32_32x32x16_bf16 v[68:83], v[52:55], v[248:251], v[68:83]
    v_mfma_f32_32x32x16_bf16 v[84:99], v[248:251], v[56:59], v[84:99]
    ds_read_b128 v[108:111], v23 offset:64
    s_waitcnt lgkmcnt(2)
    v_mfma_f32_32x32x16_bf16 v[68:83], v[60:63], v[252:255], v[68:83]
    v_mfma_f32_32x32x16_bf16 v[84:99], v[252:255], v[64:67], v[84:99]
    ds_read_b128 v[112:115], v23 offset:96
    s_lshl_b32 s47, s45, 5
    s_add_u32 s47, s47, s44
    s_lshl_b32 s47, s47, 2
    s_add_u32 s47, s47, s3
    s_lshl_b32 s47, s47, 10
    s_add_u32 s54, s47, 4194304
    s_add_u32 s55, s47, 4259840
    s_add_u32 s56, s47, 6291456
    v_lshrrev_b32 v3, 5, v1
    v_lshlrev_b32 v3, 8, v3
    v_and_b32 v2, 15, v1
    v_lshl_add_u32 v5, v2, 4, v3
    v_bfe_u32 v2, v1, 4, 1
    v_lshl_add_u32 v6, v2, 16, v5
    v_lshl_add_u32 v7, v2, 10, v5
    v_add_u32 v7, s50, v7
    v_add_u32 v8, s50, v24
    v_and_b32 v2, 15, v1
    v_lshlrev_b32 v11, 4, v2
    s_waitcnt lgkmcnt(0)
    v_pk_mul_f32 v[68:69], v[68:69], v[22:23] op_sel_hi:[1,0]
    v_pk_mul_f32 v[70:71], v[70:71], v[22:23] op_sel_hi:[1,0]
    v_pk_mul_f32 v[72:73], v[72:73], v[22:23] op_sel_hi:[1,0]
    v_pk_mul_f32 v[74:75], v[74:75], v[22:23] op_sel_hi:[1,0]
    v_cvt_pk_bf16_f32 v60, v68, v69
    v_cvt_pk_bf16_f32 v61, v70, v71
    v_cvt_pk_bf16_f32 v62, v72, v73
    v_cvt_pk_bf16_f32 v63, v74, v75
    buffer_store_dwordx4 v[60:63], v24, s[28:31], s54 offen sc1
    v_pk_mul_f32 v[76:77], v[76:77], v[22:23] op_sel_hi:[1,0]
    v_pk_mul_f32 v[78:79], v[78:79], v[22:23] op_sel_hi:[1,0]
    v_pk_mul_f32 v[80:81], v[80:81], v[22:23] op_sel_hi:[1,0]
    v_pk_mul_f32 v[82:83], v[82:83], v[22:23] op_sel_hi:[1,0]
    v_cvt_pk_bf16_f32 v64, v76, v77
    v_cvt_pk_bf16_f32 v65, v78, v79
    v_cvt_pk_bf16_f32 v66, v80, v81
    v_cvt_pk_bf16_f32 v67, v82, v83
    buffer_store_dwordx4 v[64:67], v24, s[28:31], s55 offen sc1
    v_pk_mul_f32 v[84:85], v[84:85], v[100:101]
    v_pk_mul_f32 v[86:87], v[86:87], v[102:103]
    v_pk_mul_f32 v[88:89], v[88:89], v[104:105]
    v_pk_mul_f32 v[90:91], v[90:91], v[106:107]
    v_cvt_pk_bf16_f32 v68, v84, v85
    v_cvt_pk_bf16_f32 v69, v86, v87
    v_cvt_pk_bf16_f32 v70, v88, v89
    v_cvt_pk_bf16_f32 v71, v90, v91
    buffer_store_dwordx4 v[68:71], v6, s[28:31], s56 offen offset:0 sc1
    v_pk_mul_f32 v[92:93], v[92:93], v[108:109]
    v_pk_mul_f32 v[94:95], v[94:95], v[110:111]
    v_pk_mul_f32 v[96:97], v[96:97], v[112:113]
    v_pk_mul_f32 v[98:99], v[98:99], v[114:115]
    v_cvt_pk_bf16_f32 v72, v92, v93
    v_cvt_pk_bf16_f32 v73, v94, v95
    v_cvt_pk_bf16_f32 v74, v96, v97
    v_cvt_pk_bf16_f32 v75, v98, v99
    buffer_store_dwordx4 v[72:75], v6, s[28:31], s56 offen offset:512 sc1
    buffer_load_dword v12, v11, s[36:39], 0 offen sc1
    s_waitcnt vmcnt(7) lgkmcnt(0)
    s_barrier
    ds_read_b64_tr_b16 v[36:37], v15 offset:10240
    ds_read_b64_tr_b16 v[38:39], v15 offset:10496
    ds_read_b64_tr_b16 v[40:41], v15 offset:26624
    ds_read_b64_tr_b16 v[42:43], v15 offset:26880
    ds_read_b64_tr_b16 v[44:45], v15 offset:43008
    ds_read_b64_tr_b16 v[46:47], v15 offset:43264
    ds_read_b64_tr_b16 v[48:49], v15 offset:59392
    ds_read_b64_tr_b16 v[50:51], v15 offset:59648
    s_waitcnt lgkmcnt(6)
    v_mfma_f32_32x32x16_bf16 v[100:115], v[36:39], v[128:131], 0
    ds_read_b64_tr_b16 v[52:53], v15 offset:11264
    ds_read_b64_tr_b16 v[54:55], v15 offset:11520
    ds_write_b128 v8, v[60:63] offset:4096
    s_waitcnt lgkmcnt(7)
    v_mfma_f32_32x32x16_bf16 v[76:91], v[40:43], v[132:135], 0
    ds_read_b64_tr_b16 v[56:57], v15 offset:27648
    ds_read_b64_tr_b16 v[58:59], v15 offset:27904
    ds_write_b128 v8, v[64:67] offset:5120
    s_waitcnt lgkmcnt(8)
    v_mfma_f32_32x32x16_bf16 v[100:115], v[44:47], v[136:139], v[100:115]
    ds_read_b64_tr_b16 v[36:37], v15 offset:44032
    ds_read_b64_tr_b16 v[38:39], v15 offset:44288
    ds_write_b128 v7, v[68:71] offset:6144
    s_waitcnt lgkmcnt(9)
    v_mfma_f32_32x32x16_bf16 v[76:91], v[48:51], v[140:143], v[76:91]
    ds_read_b64_tr_b16 v[40:41], v15 offset:60416
    ds_read_b64_tr_b16 v[42:43], v15 offset:60672
    ds_write_b128 v7, v[72:75] offset:6656
    s_waitcnt lgkmcnt(10)
    v_mfma_f32_32x32x16_bf16 v[100:115], v[52:55], v[144:147], v[100:115]
    ds_read_b64_tr_b16 v[44:45], v15 offset:12288
    ds_read_b64_tr_b16 v[46:47], v15 offset:12544
    v_mul_f32 v22, 0x3eb8aa3b, v22
    s_and_b32 s70, s3, 1
    s_lshr_b32 s71, s3, 1
    s_waitcnt lgkmcnt(9)
    v_mfma_f32_32x32x16_bf16 v[76:91], v[56:59], v[148:151], v[76:91]
    ds_read_b64_tr_b16 v[48:49], v15 offset:28672
    ds_read_b64_tr_b16 v[50:51], v15 offset:28928
    s_lshl_b32 s47, s70, 10
    s_lshl_b32 s48, s71, 15
    s_add_u32 s47, s47, s48
    s_waitcnt lgkmcnt(8)
    v_mfma_f32_32x32x16_bf16 v[100:115], v[36:39], v[152:155], v[100:115]
    ds_read_b64_tr_b16 v[52:53], v15 offset:45056
    ds_read_b64_tr_b16 v[54:55], v15 offset:45312
    v_add_u32 v9, s47, v24
    v_add_u32 v10, s47, v5
    v_xor_b32 v25, 0x8000, v9
    s_waitcnt lgkmcnt(7)
    v_mfma_f32_32x32x16_bf16 v[76:91], v[40:43], v[156:159], v[76:91]
    ds_read_b64_tr_b16 v[56:57], v15 offset:61440
    ds_read_b64_tr_b16 v[58:59], v15 offset:61696
    s_lshl_b32 s47, s45, 1
    s_add_u32 s70, s70, s47
    s_lshl_b32 s47, s70, 16
    s_waitcnt lgkmcnt(6)
    v_mfma_f32_32x32x16_bf16 v[100:115], v[44:47], v[160:163], v[100:115]
    ds_read_b64_tr_b16 v[36:37], v15 offset:13312
    ds_read_b64_tr_b16 v[38:39], v15 offset:13568
    s_add_u32 s48, s47, 4194304
    v_add_u32 v26, s48, v24
    s_add_u32 s48, s47, 6291456
    s_waitcnt lgkmcnt(6)
    v_mfma_f32_32x32x16_bf16 v[76:91], v[48:51], v[164:167], v[76:91]
    ds_read_b64_tr_b16 v[40:41], v15 offset:29696
    ds_read_b64_tr_b16 v[42:43], v15 offset:29952
    v_add_u32 v27, s48, v5
    s_add_u32 s67, s44, 1
    s_and_b32 s67, s67, 15
    s_waitcnt lgkmcnt(6)
    v_mfma_f32_32x32x16_bf16 v[100:115], v[52:55], v[168:171], v[100:115]
    ds_read_b64_tr_b16 v[44:45], v15 offset:46080
    ds_read_b64_tr_b16 v[46:47], v15 offset:46336
    s_lshl_b32 s67, s67, 1
    s_add_u32 s67, s67, s71
    s_lshl_b32 s67, s67, 11
    s_waitcnt lgkmcnt(6)
    v_mfma_f32_32x32x16_bf16 v[76:91], v[56:59], v[172:175], v[76:91]
    ds_read_b64_tr_b16 v[48:49], v15 offset:62464
    ds_read_b64_tr_b16 v[50:51], v15 offset:62720
    s_mov_b32 s68, 0x0000ffff
    s_mov_b32 s69, 0x0000ffff
    v_lshrrev_b32 v2, 1, v1
    s_waitcnt lgkmcnt(6)
    v_mfma_f32_32x32x16_bf16 v[100:115], v[36:39], v[176:179], v[100:115]
    ds_read_b64_tr_b16 v[52:53], v15 offset:14336
    ds_read_b64_tr_b16 v[54:55], v15 offset:14592
    v_add3_u32 v2, v2, s44, 1
    v_and_b32 v2, 15, v2
    v_lshlrev_b32 v2, 11, v2
    s_waitcnt lgkmcnt(6)
    v_mfma_f32_32x32x16_bf16 v[76:91], v[40:43], v[180:183], v[76:91]
    ds_read_b64_tr_b16 v[56:57], v15 offset:30720
    ds_read_b64_tr_b16 v[58:59], v15 offset:30976
    v_and_b32 v3, 1, v1
    v_lshl_add_u32 v2, v3, 2, v2
    s_lshl_b32 s47, s45, 7
    s_waitcnt lgkmcnt(6)
    v_mfma_f32_32x32x16_bf16 v[100:115], v[44:47], v[184:187], v[100:115]
    ds_read_b64_tr_b16 v[36:37], v15 offset:47104
    ds_read_b64_tr_b16 v[38:39], v15 offset:47360
    s_lshl_b32 s48, s71, 3
    s_add_u32 s47, s47, s48
    s_add_u32 s47, s47, 20971520
    s_waitcnt lgkmcnt(6)
    v_mfma_f32_32x32x16_bf16 v[76:91], v[48:51], v[188:191], v[76:91]
    ds_read_b64_tr_b16 v[40:41], v15 offset:63488
    ds_read_b64_tr_b16 v[42:43], v15 offset:63744
    v_add_u32 v13, s47, v2
    v_and_b32 v2, 27, v1
    v_mov_b32 v3, s49
    s_waitcnt lgkmcnt(6)
    v_mfma_f32_32x32x16_bf16 v[100:115], v[52:55], v[192:195], v[100:115]
    ds_read_b64_tr_b16 v[44:45], v15 offset:15360
    ds_read_b64_tr_b16 v[46:47], v15 offset:15616
    v_cmp_eq_u32 vcc, 16, v2
    s_nop 1
    v_cndmask_b32 v23, 0, v3, vcc
    s_waitcnt lgkmcnt(6)
    v_mfma_f32_32x32x16_bf16 v[76:91], v[56:59], v[196:199], v[76:91]
    ds_read_b64_tr_b16 v[48:49], v15 offset:31744
    ds_read_b64_tr_b16 v[50:51], v15 offset:32000
    s_waitcnt lgkmcnt(6)
    v_mfma_f32_32x32x16_bf16 v[100:115], v[36:39], v[200:203], v[100:115]
    ds_read_b64_tr_b16 v[52:53], v15 offset:48128
    ds_read_b64_tr_b16 v[54:55], v15 offset:48384
    v_mov_b32 v124, v23
    v_mov_b32 v125, v23
    v_mov_b32 v126, v23
    v_mov_b32 v127, v23
    s_waitcnt lgkmcnt(6)
    v_mfma_f32_32x32x16_bf16 v[76:91], v[40:43], v[204:207], v[76:91]
    ds_read_b64_tr_b16 v[56:57], v15 offset:64512
    ds_read_b64_tr_b16 v[58:59], v15 offset:64768
    v_mov_b32 v128, v23
    v_mov_b32 v129, v23
    v_mov_b32 v130, v23
    v_mov_b32 v131, v23
    s_waitcnt vmcnt(5)
    s_barrier
    s_waitcnt lgkmcnt(6)
    v_mfma_f32_32x32x16_bf16 v[100:115], v[44:47], v[208:211], v[100:115]
    ds_read_b64_tr_b16 v[36:37], v15 offset:0
    ds_read_b64_tr_b16 v[38:39], v15 offset:256
    v_mov_b32 v136, v23
    v_mov_b32 v137, v23
    v_mov_b32 v138, v23
    v_mov_b32 v139, v23
    s_waitcnt vmcnt(1)
    s_lshl_b32 s72, s3, 2
    s_add_u32 s72, s72, s52
    v_mov_b32 v28, 0
    v_mov_b32 v29, 1
    s_mov_b64 exec, 1
    buffer_store_dword v29, v28, s[28:31], s72 offen offset:0 sc1
    s_mov_b64 exec, -1
    s_waitcnt lgkmcnt(6)
    v_mfma_f32_32x32x16_bf16 v[76:91], v[48:51], v[212:215], v[76:91]
    ds_read_b64_tr_b16 v[40:41], v15 offset:16384
    ds_read_b64_tr_b16 v[42:43], v15 offset:16640
    v_mov_b32 v140, v23
    v_mov_b32 v141, v23
    v_mov_b32 v142, v23
    v_mov_b32 v143, v23
    s_waitcnt lgkmcnt(6)
    v_mfma_f32_32x32x16_bf16 v[100:115], v[52:55], v[216:219], v[100:115]
    ds_read_b64_tr_b16 v[44:45], v15 offset:32768
    ds_read_b64_tr_b16 v[46:47], v15 offset:33024
    v_mov_b32 v148, v23
    v_mov_b32 v149, v23
    v_mov_b32 v150, v23
    v_mov_b32 v151, v23
    s_waitcnt lgkmcnt(6)
    v_mfma_f32_32x32x16_bf16 v[76:91], v[56:59], v[220:223], v[76:91]
    ds_read_b64_tr_b16 v[48:49], v15 offset:49152
    ds_read_b64_tr_b16 v[50:51], v15 offset:49408
    v_mov_b32 v152, v23
    v_mov_b32 v153, v23
    v_mov_b32 v154, v23
    v_mov_b32 v155, v23
    s_waitcnt lgkmcnt(6)
    v_mfma_f32_32x32x16_bf16 v[100:115], v[36:39], v[224:227], v[100:115]
    ds_read_b64_tr_b16 v[52:53], v15 offset:1024
    ds_read_b64_tr_b16 v[54:55], v15 offset:1280
    v_mov_b32 v160, v23
    v_mov_b32 v161, v23
    v_mov_b32 v162, v23
    v_mov_b32 v163, v23
    s_waitcnt lgkmcnt(6)
    v_mfma_f32_32x32x16_bf16 v[76:91], v[40:43], v[228:231], v[76:91]
    ds_read_b64_tr_b16 v[56:57], v15 offset:17408
    ds_read_b64_tr_b16 v[58:59], v15 offset:17664
    v_mov_b32 v164, v23
    v_mov_b32 v165, v23
    v_mov_b32 v166, v23
    v_mov_b32 v167, v23
    s_waitcnt lgkmcnt(6)
    v_mfma_f32_32x32x16_bf16 v[100:115], v[44:47], v[232:235], v[100:115]
    ds_read_b64_tr_b16 v[36:37], v15 offset:33792
    ds_read_b64_tr_b16 v[38:39], v15 offset:34048
    v_mov_b32 v172, v23
    v_mov_b32 v173, v23
    v_mov_b32 v174, v23
    v_mov_b32 v175, v23
    s_waitcnt lgkmcnt(6)
    v_mfma_f32_32x32x16_bf16 v[76:91], v[48:51], v[236:239], v[76:91]
    ds_read_b64_tr_b16 v[40:41], v15 offset:50176
    ds_read_b64_tr_b16 v[42:43], v15 offset:50432
    v_mov_b32 v176, v23
    v_mov_b32 v177, v23
    v_mov_b32 v178, v23
    v_mov_b32 v179, v23
    s_waitcnt lgkmcnt(6)
    v_mfma_f32_32x32x16_bf16 v[100:115], v[52:55], v[240:243], v[100:115]
    v_mov_b32 v184, v23
    v_mov_b32 v185, v23
    v_mov_b32 v186, v23
    v_mov_b32 v187, v23
    s_waitcnt lgkmcnt(4)
    v_mfma_f32_32x32x16_bf16 v[76:91], v[56:59], v[244:247], v[76:91]
    v_mov_b32 v188, v23
    v_mov_b32 v189, v23
    v_mov_b32 v190, v23
    v_mov_b32 v191, v23
    s_waitcnt lgkmcnt(2)
    v_mfma_f32_32x32x16_bf16 v[100:115], v[36:39], v[248:251], v[100:115]
    s_waitcnt lgkmcnt(0)
    v_mfma_f32_32x32x16_bf16 v[76:91], v[40:43], v[252:255], v[76:91]
    s_nop 11
    v_pk_add_f32 v[100:101], v[76:77], v[100:101]
    v_pk_add_f32 v[102:103], v[78:79], v[102:103]
    v_pk_add_f32 v[104:105], v[80:81], v[104:105]
    v_pk_add_f32 v[106:107], v[82:83], v[106:107]
    v_pk_add_f32 v[108:109], v[84:85], v[108:109]
    v_pk_add_f32 v[110:111], v[86:87], v[110:111]
    v_pk_add_f32 v[112:113], v[88:89], v[112:113]
    v_pk_add_f32 v[114:115], v[90:91], v[114:115]
    v_pk_mul_f32 v[100:101], v[100:101], v[22:23] op_sel_hi:[1,0]
    v_pk_mul_f32 v[102:103], v[102:103], v[22:23] op_sel_hi:[1,0]
    v_pk_mul_f32 v[104:105], v[104:105], v[22:23] op_sel_hi:[1,0]
    v_pk_mul_f32 v[106:107], v[106:107], v[22:23] op_sel_hi:[1,0]
    v_pk_mul_f32 v[108:109], v[108:109], v[22:23] op_sel_hi:[1,0]
    v_pk_mul_f32 v[110:111], v[110:111], v[22:23] op_sel_hi:[1,0]
    v_pk_mul_f32 v[112:113], v[112:113], v[22:23] op_sel_hi:[1,0]
    v_pk_mul_f32 v[114:115], v[114:115], v[22:23] op_sel_hi:[1,0]
    v_cvt_pk_bf16_f32 v100, v100, v101
    v_cvt_pk_bf16_f32 v101, v102, v103
    v_cvt_pk_bf16_f32 v102, v104, v105
    v_cvt_pk_bf16_f32 v103, v106, v107
    ds_write_b128 v8, v[100:103] offset:8192
    v_cvt_pk_bf16_f32 v104, v108, v109
    v_cvt_pk_bf16_f32 v105, v110, v111
    v_cvt_pk_bf16_f32 v106, v112, v113
    v_cvt_pk_bf16_f32 v107, v114, v115
    ds_write_b128 v8, v[104:107] offset:9216
    s_waitcnt vmcnt(1)
    v_cmp_ne_u32 vcc, 16, v12
    s_cbranch_vccz fa_cnt_skip
    s_mov_b32 s51, 32768
fa_cnt:
    buffer_load_dword v12, v11, s[36:39], 0 offen sc1
fa_cnt_chk:
    s_waitcnt vmcnt(0)
    v_cmp_ne_u32 vcc, 16, v12
    s_cbranch_vccz fa_cnt_ok
    s_sub_u32 s51, s51, 1
    s_cmp_lg_u32 s51, 0
    s_cbranch_scc1 fa_cnt
fa_cnt_ok:
fa_cnt_skip:
    s_waitcnt lgkmcnt(0)
    s_barrier
    ds_read_b128 v[120:123], v9 offset:4096
    ds_read_b128 v[44:47], v25 offset:8192
    ds_read_b128 v[48:51], v25 offset:24576
    ds_read_b128 v[52:55], v9 offset:8192
    ds_read_b128 v[56:59], v9 offset:24576
    ds_read_b128 v[132:135], v9 offset:20480
    s_mov_b64 exec, s[68:69]
    ds_read_b128 v[124:127], v10 offset:6144
    ds_read_b128 v[128:131], v10 offset:6656
    ds_read_b128 v[136:139], v10 offset:22528
    ds_read_b128 v[140:143], v10 offset:23040
    s_mov_b64 exec, -1
    buffer_load_dword v14, v13, s[28:31], 0 offen sc1
    s_waitcnt lgkmcnt(8)
    v_mfma_f32_32x32x16_bf16 v[60:75], v[120:123], v[44:47], 0
    s_lshl_b32 s47, s3, 2
    s_add_u32 s47, s47, 160256
    v_mov_b32 v2, s47
    v_mov_b32 v3, 64
    s_waitcnt lgkmcnt(0)
    ds_write_b32 v2, v3
    v_mfma_f32_32x32x16_bf16 v[76:91], v[120:123], v[48:51], 0
    s_nop 4
    v_exp_f32 v28, v60
    v_exp_f32 v29, v61
    v_exp_f32 v30, v62
    v_cvt_pk_bf16_f32 v36, v28, v29
    v_exp_f32 v31, v63
    v_exp_f32 v32, v64
    v_cvt_pk_bf16_f32 v37, v30, v31
    v_exp_f32 v33, v65
    v_exp_f32 v28, v66
    v_cvt_pk_bf16_f32 v38, v32, v33
    v_exp_f32 v29, v67
    v_exp_f32 v30, v68
    v_cvt_pk_bf16_f32 v39, v28, v29
    v_exp_f32 v31, v69
    v_exp_f32 v32, v70
    v_mfma_f32_32x32x16_bf16 v[192:207], v[124:127], v[36:39], 0
    v_cvt_pk_bf16_f32 v40, v30, v31
    v_exp_f32 v33, v71
    v_exp_f32 v28, v72
    v_cvt_pk_bf16_f32 v41, v32, v33
    v_exp_f32 v29, v73
    v_exp_f32 v30, v74
    v_cvt_pk_bf16_f32 v42, v28, v29
    v_exp_f32 v31, v75
    v_mfma_f32_32x32x16_bf16 v[60:75], v[120:123], v[52:55], 0
    v_cvt_pk_bf16_f32 v43, v30, v31
    v_exp_f32 v28, v76
    v_exp_f32 v29, v77
    v_exp_f32 v30, v78
    v_cvt_pk_bf16_f32 v36, v28, v29
    v_exp_f32 v31, v79
    v_exp_f32 v32, v80
    v_cvt_pk_bf16_f32 v37, v30, v31
    v_mfma_f32_32x32x16_bf16 v[192:207], v[128:131], v[40:43], v[192:207]
    v_exp_f32 v33, v81
    v_exp_f32 v28, v82
    v_cvt_pk_bf16_f32 v38, v32, v33
    v_exp_f32 v29, v83
    v_exp_f32 v30, v84
    v_cvt_pk_bf16_f32 v39, v28, v29
    v_exp_f32 v31, v85
    v_exp_f32 v32, v86
    v_mfma_f32_32x32x16_bf16 v[208:223], v[124:127], v[36:39], 0
    v_cvt_pk_bf16_f32 v40, v30, v31
    v_exp_f32 v33, v87
    v_exp_f32 v28, v88
    v_cvt_pk_bf16_f32 v41, v32, v33
    v_exp_f32 v29, v89
    v_exp_f32 v30, v90
    v_cvt_pk_bf16_f32 v42, v28, v29
    v_exp_f32 v31, v91
    v_mfma_f32_32x32x16_bf16 v[76:91], v[120:123], v[56:59], 0
    v_cvt_pk_bf16_f32 v43, v30, v31
    v_exp_f32 v28, v60
    v_exp_f32 v29, v61
    v_exp_f32 v30, v62
    v_cvt_pk_bf16_f32 v36, v28, v29
    v_exp_f32 v31, v63
    v_exp_f32 v32, v64
    v_cvt_pk_bf16_f32 v37, v30, v31
    v_mfma_f32_32x32x16_bf16 v[208:223], v[128:131], v[40:43], v[208:223]
    v_exp_f32 v33, v65
    v_exp_f32 v28, v66
    v_cvt_pk_bf16_f32 v38, v32, v33
    v_exp_f32 v29, v67
    v_exp_f32 v30, v68
    v_cvt_pk_bf16_f32 v39, v28, v29
    v_exp_f32 v31, v69
    v_exp_f32 v32, v70
    v_mfma_f32_32x32x16_bf16 v[224:239], v[124:127], v[36:39], 0
    v_cvt_pk_bf16_f32 v40, v30, v31
    v_exp_f32 v33, v71
    v_exp_f32 v28, v72
    v_cvt_pk_bf16_f32 v41, v32, v33
    v_exp_f32 v29, v73
    v_exp_f32 v30, v74
    v_cvt_pk_bf16_f32 v42, v28, v29
    v_exp_f32 v31, v75
    v_mfma_f32_32x32x16_bf16 v[60:75], v[132:135], v[44:47], 0
    s_waitcnt vmcnt(0)
    v_cmp_eq_u32 vcc, 1, v14
    s_mov_b32 s73, 3
    s_mov_b32 s75, 32768
    s_mov_b32 s74, vcc_lo
    s_andn2_b32 s72, s73, s74
    s_cbranch_scc1 fa_kvp0
fa_kvr0:
    buffer_load_dwordx4 v[144:147], v26, s[28:31], s67 offen sc1
    s_mov_b64 exec, s[68:69]
    buffer_load_dwordx4 v[148:151], v27, s[28:31], s67 offen sc1
    buffer_load_dwordx4 v[152:155], v27, s[28:31], s67 offen offset:512 sc1
    s_mov_b64 exec, -1
    s_add_u32 s67, s67, 1024
    buffer_load_dwordx4 v[156:159], v26, s[28:31], s67 offen sc1
    s_mov_b64 exec, s[68:69]
    buffer_load_dwordx4 v[160:163], v27, s[28:31], s67 offen sc1
    buffer_load_dwordx4 v[164:167], v27, s[28:31], s67 offen offset:512 sc1
    s_mov_b64 exec, -1
    s_add_u32 s67, s67, 3072
    s_and_b32 s67, s67, 0xffff
    v_cvt_pk_bf16_f32 v43, v30, v31
    v_exp_f32 v28, v76
    v_exp_f32 v29, v77
    v_exp_f32 v30, v78
    v_cvt_pk_bf16_f32 v36, v28, v29
    v_exp_f32 v31, v79
    v_exp_f32 v32, v80
    v_cvt_pk_bf16_f32 v37, v30, v31
    v_mfma_f32_32x32x16_bf16 v[224:239], v[128:131], v[40:43], v[224:239]
    v_exp_f32 v33, v81
    v_exp_f32 v28, v82
    v_cvt_pk_bf16_f32 v38, v32, v33
    v_exp_f32 v29, v83
    v_exp_f32 v30, v84
    v_cvt_pk_bf16_f32 v39, v28, v29
    v_exp_f32 v31, v85
    v_exp_f32 v32, v86
    v_mfma_f32_32x32x16_bf16 v[240:255], v[124:127], v[36:39], 0
    v_cvt_pk_bf16_f32 v40, v30, v31
    v_exp_f32 v33, v87
    v_exp_f32 v28, v88
    v_cvt_pk_bf16_f32 v41, v32, v33
    v_exp_f32 v29, v89
    v_exp_f32 v30, v90
    v_cvt_pk_bf16_f32 v42, v28, v29
    v_exp_f32 v31, v91
    s_lshl_b32 s73, s73, 2
    s_andn2_b32 s72, s73, s74
    s_cbranch_scc1 fa_kvp1
fa_kvr1:
    buffer_load_dwordx4 v[168:171], v26, s[28:31], s67 offen sc1
    s_mov_b64 exec, s[68:69]
    buffer_load_dwordx4 v[172:175], v27, s[28:31], s67 offen sc1
    buffer_load_dwordx4 v[176:179], v27, s[28:31], s67 offen offset:512 sc1
    s_mov_b64 exec, -1
    s_add_u32 s67, s67, 1024
    buffer_load_dwordx4 v[180:183], v26, s[28:31], s67 offen sc1
    s_mov_b64 exec, s[68:69]
    buffer_load_dwordx4 v[184:187], v27, s[28:31], s67 offen sc1
    buffer_load_dwordx4 v[188:191], v27, s[28:31], s67 offen offset:512 sc1
    s_mov_b64 exec, -1
    s_add_u32 s67, s67, 3072
    s_and_b32 s67, s67, 0xffff
    v_mfma_f32_32x32x16_bf16 v[76:91], v[132:135], v[48:51], 0
    s_lshl_b32 s73, s73, 2
    s_andn2_b32 s72, s73, s74
    s_cbranch_scc1 fa_kvp2
fa_kvr2:
    v_cvt_pk_bf16_f32 v43, v30, v31
    v_exp_f32 v28, v60
    v_exp_f32 v29, v61
    v_exp_f32 v30, v62
    v_cvt_pk_bf16_f32 v36, v28, v29
    v_exp_f32 v31, v63
    v_exp_f32 v32, v64
    v_cvt_pk_bf16_f32 v37, v30, v31
    v_mfma_f32_32x32x16_bf16 v[240:255], v[128:131], v[40:43], v[240:255]
    buffer_load_dwordx4 v[120:123], v26, s[28:31], s67 offen sc1
    s_mov_b64 exec, s[68:69]
    buffer_load_dwordx4 v[124:127], v27, s[28:31], s67 offen sc1
    buffer_load_dwordx4 v[128:131], v27, s[28:31], s67 offen offset:512 sc1
    s_mov_b64 exec, -1
    v_exp_f32 v33, v65
    v_exp_f32 v28, v66
    v_cvt_pk_bf16_f32 v38, v32, v33
    v_exp_f32 v29, v67
    v_exp_f32 v30, v68
    v_cvt_pk_bf16_f32 v39, v28, v29
    v_exp_f32 v31, v69
    v_exp_f32 v32, v70
    v_mfma_f32_32x32x16_bf16 v[192:207], v[136:139], v[36:39], v[192:207]
    s_add_u32 s67, s67, 1024
    v_cvt_pk_bf16_f32 v40, v30, v31
    v_exp_f32 v33, v71
    v_exp_f32 v28, v72
    v_cvt_pk_bf16_f32 v41, v32, v33
    v_exp_f32 v29, v73
    v_exp_f32 v30, v74
    v_cvt_pk_bf16_f32 v42, v28, v29
    v_exp_f32 v31, v75
    v_mfma_f32_32x32x16_bf16 v[60:75], v[132:135], v[52:55], 0
    v_cvt_pk_bf16_f32 v43, v30, v31
    v_exp_f32 v28, v76
    v_exp_f32 v29, v77
    v_exp_f32 v30, v78
    v_cvt_pk_bf16_f32 v36, v28, v29
    v_exp_f32 v31, v79
    v_exp_f32 v32, v80
    v_cvt_pk_bf16_f32 v37, v30, v31
    v_mfma_f32_32x32x16_bf16 v[192:207], v[140:143], v[40:43], v[192:207]
    v_exp_f32 v33, v81
    v_exp_f32 v28, v82
    v_cvt_pk_bf16_f32 v38, v32, v33
    v_exp_f32 v29, v83
    v_exp_f32 v30, v84
    v_cvt_pk_bf16_f32 v39, v28, v29
    v_exp_f32 v31, v85
    v_exp_f32 v32, v86
    v_mfma_f32_32x32x16_bf16 v[208:223], v[136:139], v[36:39], v[208:223]
    v_cvt_pk_bf16_f32 v40, v30, v31
    v_exp_f32 v33, v87
    v_exp_f32 v28, v88
    v_cvt_pk_bf16_f32 v41, v32, v33
    v_exp_f32 v29, v89
    v_exp_f32 v30, v90
    v_cvt_pk_bf16_f32 v42, v28, v29
    v_exp_f32 v31, v91
    v_mfma_f32_32x32x16_bf16 v[76:91], v[132:135], v[56:59], 0
    v_cvt_pk_bf16_f32 v43, v30, v31
    v_exp_f32 v28, v60
    v_exp_f32 v29, v61
    v_exp_f32 v30, v62
    v_cvt_pk_bf16_f32 v36, v28, v29
    v_exp_f32 v31, v63
    v_exp_f32 v32, v64
    v_cvt_pk_bf16_f32 v37, v30, v31
    v_mfma_f32_32x32x16_bf16 v[208:223], v[140:143], v[40:43], v[208:223]
    v_exp_f32 v33, v65
    v_exp_f32 v28, v66
    v_cvt_pk_bf16_f32 v38, v32, v33
    v_exp_f32 v29, v67
    v_exp_f32 v30, v68
    v_cvt_pk_bf16_f32 v39, v28, v29
    v_exp_f32 v31, v69
    v_exp_f32 v32, v70
    v_mfma_f32_32x32x16_bf16 v[224:239], v[136:139], v[36:39], v[224:239]
    s_waitcnt vmcnt(12)
    v_cvt_pk_bf16_f32 v40, v30, v31
    v_exp_f32 v33, v71
    v_exp_f32 v28, v72
    v_cvt_pk_bf16_f32 v41, v32, v33
    v_exp_f32 v29, v73
    v_exp_f32 v30, v74
    v_cvt_pk_bf16_f32 v42, v28, v29
    v_exp_f32 v31, v75
    v_mfma_f32_32x32x16_bf16 v[60:75], v[144:147], v[44:47], 0
    v_cvt_pk_bf16_f32 v43, v30, v31
    v_exp_f32 v28, v76
    v_exp_f32 v29, v77
    v_exp_f32 v30, v78
    v_cvt_pk_bf16_f32 v36, v28, v29
    v_exp_f32 v31, v79
    v_exp_f32 v32, v80
    v_cvt_pk_bf16_f32 v37, v30, v31
    v_mfma_f32_32x32x16_bf16 v[224:239], v[140:143], v[40:43], v[224:239]
    v_exp_f32 v33, v81
    v_exp_f32 v28, v82
    v_cvt_pk_bf16_f32 v38, v32, v33
    v_exp_f32 v29, v83
    v_exp_f32 v30, v84
    v_cvt_pk_bf16_f32 v39, v28, v29
    v_exp_f32 v31, v85
    v_exp_f32 v32, v86
    v_mfma_f32_32x32x16_bf16 v[240:255], v[136:139], v[36:39], v[240:255]
    v_cvt_pk_bf16_f32 v40, v30, v31
    v_exp_f32 v33, v87
    v_exp_f32 v28, v88
    v_cvt_pk_bf16_f32 v41, v32, v33
    v_exp_f32 v29, v89
    v_exp_f32 v30, v90
    v_cvt_pk_bf16_f32 v42, v28, v29
    v_exp_f32 v31, v91
    s_mov_b32 s51, 5
.p2align 6
fa_loop:
    v_mfma_f32_32x32x16_bf16 v[76:91], v[144:147], v[48:51], 0
    v_cvt_pk_bf16_f32 v43, v30, v31
    v_exp_f32 v28, v60
    v_exp_f32 v29, v61
    v_exp_f32 v30, v62
    v_cvt_pk_bf16_f32 v36, v28, v29
    v_exp_f32 v31, v63
    v_exp_f32 v32, v64
    v_cvt_pk_bf16_f32 v37, v30, v31
    v_mfma_f32_32x32x16_bf16 v[240:255], v[140:143], v[40:43], v[240:255]
    buffer_load_dwordx4 v[132:135], v26, s[28:31], s67 offen sc1
    s_mov_b64 exec, s[68:69]
    buffer_load_dwordx4 v[136:139], v27, s[28:31], s67 offen sc1
    buffer_load_dwordx4 v[140:143], v27, s[28:31], s67 offen offset:512 sc1
    s_mov_b64 exec, -1
    v_exp_f32 v33, v65
    v_exp_f32 v28, v66
    v_cvt_pk_bf16_f32 v38, v32, v33
    v_exp_f32 v29, v67
    v_exp_f32 v30, v68
    v_cvt_pk_bf16_f32 v39, v28, v29
    v_exp_f32 v31, v69
    v_exp_f32 v32, v70
    v_mfma_f32_32x32x16_bf16 v[192:207], v[148:151], v[36:39], v[192:207]
    s_add_u32 s67, s67, 3072
    v_cvt_pk_bf16_f32 v40, v30, v31
    v_exp_f32 v33, v71
    v_exp_f32 v28, v72
    v_cvt_pk_bf16_f32 v41, v32, v33
    v_exp_f32 v29, v73
    v_exp_f32 v30, v74
    v_cvt_pk_bf16_f32 v42, v28, v29
    v_exp_f32 v31, v75
    v_mfma_f32_32x32x16_bf16 v[60:75], v[144:147], v[52:55], 0
    s_and_b32 s67, s67, 0xffff
    v_cvt_pk_bf16_f32 v43, v30, v31
    v_exp_f32 v28, v76
    v_exp_f32 v29, v77
    v_exp_f32 v30, v78
    v_cvt_pk_bf16_f32 v36, v28, v29
    v_exp_f32 v31, v79
    v_exp_f32 v32, v80
    v_cvt_pk_bf16_f32 v37, v30, v31
    v_mfma_f32_32x32x16_bf16 v[192:207], v[152:155], v[40:43], v[192:207]
    v_exp_f32 v33, v81
    v_exp_f32 v28, v82
    v_cvt_pk_bf16_f32 v38, v32, v33
    v_exp_f32 v29, v83
    v_exp_f32 v30, v84
    v_cvt_pk_bf16_f32 v39, v28, v29
    v_exp_f32 v31, v85
    v_exp_f32 v32, v86
    v_mfma_f32_32x32x16_bf16 v[208:223], v[148:151], v[36:39], v[208:223]
    v_cvt_pk_bf16_f32 v40, v30, v31
    v_exp_f32 v33, v87
    v_exp_f32 v28, v88
    v_cvt_pk_bf16_f32 v41, v32, v33
    v_exp_f32 v29, v89
    v_exp_f32 v30, v90
    v_cvt_pk_bf16_f32 v42, v28, v29
    v_exp_f32 v31, v91
    v_mfma_f32_32x32x16_bf16 v[76:91], v[144:147], v[56:59], 0
    v_cvt_pk_bf16_f32 v43, v30, v31
    v_exp_f32 v28, v60
    v_exp_f32 v29, v61
    v_exp_f32 v30, v62
    v_cvt_pk_bf16_f32 v36, v28, v29
    v_exp_f32 v31, v63
    v_exp_f32 v32, v64
    v_cvt_pk_bf16_f32 v37, v30, v31
    v_mfma_f32_32x32x16_bf16 v[208:223], v[152:155], v[40:43], v[208:223]
    v_exp_f32 v33, v65
    v_exp_f32 v28, v66
    v_cvt_pk_bf16_f32 v38, v32, v33
    v_exp_f32 v29, v67
    v_exp_f32 v30, v68
    v_cvt_pk_bf16_f32 v39, v28, v29
    v_exp_f32 v31, v69
    v_exp_f32 v32, v70
    v_mfma_f32_32x32x16_bf16 v[224:239], v[148:151], v[36:39], v[224:239]
    s_waitcnt vmcnt(12)
    v_cvt_pk_bf16_f32 v40, v30, v31
    v_exp_f32 v33, v71
    v_exp_f32 v28, v72
    v_cvt_pk_bf16_f32 v41, v32, v33
    v_exp_f32 v29, v73
    v_exp_f32 v30, v74
    v_cvt_pk_bf16_f32 v42, v28, v29
    v_exp_f32 v31, v75
    v_mfma_f32_32x32x16_bf16 v[60:75], v[156:159], v[44:47], 0
    v_cvt_pk_bf16_f32 v43, v30, v31
    v_exp_f32 v28, v76
    v_exp_f32 v29, v77
    v_exp_f32 v30, v78
    v_cvt_pk_bf16_f32 v36, v28, v29
    v_exp_f32 v31, v79
    v_exp_f32 v32, v80
    v_cvt_pk_bf16_f32 v37, v30, v31
    v_mfma_f32_32x32x16_bf16 v[224:239], v[152:155], v[40:43], v[224:239]
    v_exp_f32 v33, v81
    v_exp_f32 v28, v82
    v_cvt_pk_bf16_f32 v38, v32, v33
    v_exp_f32 v29, v83
    v_exp_f32 v30, v84
    v_cvt_pk_bf16_f32 v39, v28, v29
    v_exp_f32 v31, v85
    v_exp_f32 v32, v86
    v_mfma_f32_32x32x16_bf16 v[240:255], v[148:151], v[36:39], v[240:255]
    v_cvt_pk_bf16_f32 v40, v30, v31
    v_exp_f32 v33, v87
    v_exp_f32 v28, v88
    v_cvt_pk_bf16_f32 v41, v32, v33
    v_exp_f32 v29, v89
    v_exp_f32 v30, v90
    v_cvt_pk_bf16_f32 v42, v28, v29
    v_exp_f32 v31, v91
    v_mfma_f32_32x32x16_bf16 v[76:91], v[156:159], v[48:51], 0
    s_lshl_b32 s73, s73, 2
    s_andn2_b32 s72, s73, s74
    s_cbranch_scc1 fa_kvp3
fa_kvr3:
    v_cvt_pk_bf16_f32 v43, v30, v31
    v_exp_f32 v28, v60
    v_exp_f32 v29, v61
    v_exp_f32 v30, v62
    v_cvt_pk_bf16_f32 v36, v28, v29
    v_exp_f32 v31, v63
    v_exp_f32 v32, v64
    v_cvt_pk_bf16_f32 v37, v30, v31
    v_mfma_f32_32x32x16_bf16 v[240:255], v[152:155], v[40:43], v[240:255]
    buffer_load_dwordx4 v[144:147], v26, s[28:31], s67 offen sc1
    s_mov_b64 exec, s[68:69]
    buffer_load_dwordx4 v[148:151], v27, s[28:31], s67 offen sc1
    buffer_load_dwordx4 v[152:155], v27, s[28:31], s67 offen offset:512 sc1
    s_mov_b64 exec, -1
    v_exp_f32 v33, v65
    v_exp_f32 v28, v66
    v_cvt_pk_bf16_f32 v38, v32, v33
    v_exp_f32 v29, v67
    v_exp_f32 v30, v68
    v_cvt_pk_bf16_f32 v39, v28, v29
    v_exp_f32 v31, v69
    v_exp_f32 v32, v70
    v_mfma_f32_32x32x16_bf16 v[192:207], v[160:163], v[36:39], v[192:207]
    s_add_u32 s67, s67, 1024
    v_cvt_pk_bf16_f32 v40, v30, v31
    v_exp_f32 v33, v71
    v_exp_f32 v28, v72
    v_cvt_pk_bf16_f32 v41, v32, v33
    v_exp_f32 v29, v73
    v_exp_f32 v30, v74
    v_cvt_pk_bf16_f32 v42, v28, v29
    v_exp_f32 v31, v75
    v_mfma_f32_32x32x16_bf16 v[60:75], v[156:159], v[52:55], 0
    v_cvt_pk_bf16_f32 v43, v30, v31
    v_exp_f32 v28, v76
    v_exp_f32 v29, v77
    v_exp_f32 v30, v78
    v_cvt_pk_bf16_f32 v36, v28, v29
    v_exp_f32 v31, v79
    v_exp_f32 v32, v80
    v_cvt_pk_bf16_f32 v37, v30, v31
    v_mfma_f32_32x32x16_bf16 v[192:207], v[164:167], v[40:43], v[192:207]
    v_exp_f32 v33, v81
    v_exp_f32 v28, v82
    v_cvt_pk_bf16_f32 v38, v32, v33
    v_exp_f32 v29, v83
    v_exp_f32 v30, v84
    v_cvt_pk_bf16_f32 v39, v28, v29
    v_exp_f32 v31, v85
    v_exp_f32 v32, v86
    v_mfma_f32_32x32x16_bf16 v[208:223], v[160:163], v[36:39], v[208:223]
    v_cvt_pk_bf16_f32 v40, v30, v31
    v_exp_f32 v33, v87
    v_exp_f32 v28, v88
    v_cvt_pk_bf16_f32 v41, v32, v33
    v_exp_f32 v29, v89
    v_exp_f32 v30, v90
    v_cvt_pk_bf16_f32 v42, v28, v29
    v_exp_f32 v31, v91
    v_mfma_f32_32x32x16_bf16 v[76:91], v[156:159], v[56:59], 0
    v_cvt_pk_bf16_f32 v43, v30, v31
    v_exp_f32 v28, v60
    v_exp_f32 v29, v61
    v_exp_f32 v30, v62
    v_cvt_pk_bf16_f32 v36, v28, v29
    v_exp_f32 v31, v63
    v_exp_f32 v32, v64
    v_cvt_pk_bf16_f32 v37, v30, v31
    v_mfma_f32_32x32x16_bf16 v[208:223], v[164:167], v[40:43], v[208:223]
    v_exp_f32 v33, v65
    v_exp_f32 v28, v66
    v_cvt_pk_bf16_f32 v38, v32, v33
    v_exp_f32 v29, v67
    v_exp_f32 v30, v68
    v_cvt_pk_bf16_f32 v39, v28, v29
    v_exp_f32 v31, v69
    v_exp_f32 v32, v70
    v_mfma_f32_32x32x16_bf16 v[224:239], v[160:163], v[36:39], v[224:239]
    s_waitcnt vmcnt(12)
    v_cvt_pk_bf16_f32 v40, v30, v31
    v_exp_f32 v33, v71
    v_exp_f32 v28, v72
    v_cvt_pk_bf16_f32 v41, v32, v33
    v_exp_f32 v29, v73
    v_exp_f32 v30, v74
    v_cvt_pk_bf16_f32 v42, v28, v29
    v_exp_f32 v31, v75
    v_mfma_f32_32x32x16_bf16 v[60:75], v[168:171], v[44:47], 0
    v_cvt_pk_bf16_f32 v43, v30, v31
    v_exp_f32 v28, v76
    v_exp_f32 v29, v77
    v_exp_f32 v30, v78
    v_cvt_pk_bf16_f32 v36, v28, v29
    v_exp_f32 v31, v79
    v_exp_f32 v32, v80
    v_cvt_pk_bf16_f32 v37, v30, v31
    v_mfma_f32_32x32x16_bf16 v[224:239], v[164:167], v[40:43], v[224:239]
    v_exp_f32 v33, v81
    v_exp_f32 v28, v82
    v_cvt_pk_bf16_f32 v38, v32, v33
    v_exp_f32 v29, v83
    v_exp_f32 v30, v84
    v_cvt_pk_bf16_f32 v39, v28, v29
    v_exp_f32 v31, v85
    v_exp_f32 v32, v86
    v_mfma_f32_32x32x16_bf16 v[240:255], v[160:163], v[36:39], v[240:255]
    v_cvt_pk_bf16_f32 v40, v30, v31
    v_exp_f32 v33, v87
    v_exp_f32 v28, v88
    v_cvt_pk_bf16_f32 v41, v32, v33
    v_exp_f32 v29, v89
    v_exp_f32 v30, v90
    v_cvt_pk_bf16_f32 v42, v28, v29
    v_exp_f32 v31, v91
    v_mfma_f32_32x32x16_bf16 v[76:91], v[168:171], v[48:51], 0
    v_cvt_pk_bf16_f32 v43, v30, v31
    v_exp_f32 v28, v60
    v_exp_f32 v29, v61
    v_exp_f32 v30, v62
    v_cvt_pk_bf16_f32 v36, v28, v29
    v_exp_f32 v31, v63
    v_exp_f32 v32, v64
    v_cvt_pk_bf16_f32 v37, v30, v31
    v_mfma_f32_32x32x16_bf16 v[240:255], v[164:167], v[40:43], v[240:255]
    buffer_load_dwordx4 v[156:159], v26, s[28:31], s67 offen sc1
    s_mov_b64 exec, s[68:69]
    buffer_load_dwordx4 v[160:163], v27, s[28:31], s67 offen sc1
    buffer_load_dwordx4 v[164:167], v27, s[28:31], s67 offen offset:512 sc1
    s_mov_b64 exec, -1
    v_exp_f32 v33, v65
    v_exp_f32 v28, v66
    v_cvt_pk_bf16_f32 v38, v32, v33
    v_exp_f32 v29, v67
    v_exp_f32 v30, v68
    v_cvt_pk_bf16_f32 v39, v28, v29
    v_exp_f32 v31, v69
    v_exp_f32 v32, v70
    v_mfma_f32_32x32x16_bf16 v[192:207], v[172:175], v[36:39], v[192:207]
    s_add_u32 s67, s67, 3072
    v_cvt_pk_bf16_f32 v40, v30, v31
    v_exp_f32 v33, v71
    v_exp_f32 v28, v72
    v_cvt_pk_bf16_f32 v41, v32, v33
    v_exp_f32 v29, v73
    v_exp_f32 v30, v74
    v_cvt_pk_bf16_f32 v42, v28, v29
    v_exp_f32 v31, v75
    v_mfma_f32_32x32x16_bf16 v[60:75], v[168:171], v[52:55], 0
    s_and_b32 s67, s67, 0xffff
    v_cvt_pk_bf16_f32 v43, v30, v31
    v_exp_f32 v28, v76
    v_exp_f32 v29, v77
    v_exp_f32 v30, v78
    v_cvt_pk_bf16_f32 v36, v28, v29
    v_exp_f32 v31, v79
    v_exp_f32 v32, v80
    v_cvt_pk_bf16_f32 v37, v30, v31
    v_mfma_f32_32x32x16_bf16 v[192:207], v[176:179], v[40:43], v[192:207]
    v_exp_f32 v33, v81
    v_exp_f32 v28, v82
    v_cvt_pk_bf16_f32 v38, v32, v33
    v_exp_f32 v29, v83
    v_exp_f32 v30, v84
    v_cvt_pk_bf16_f32 v39, v28, v29
    v_exp_f32 v31, v85
    v_exp_f32 v32, v86
    v_mfma_f32_32x32x16_bf16 v[208:223], v[172:175], v[36:39], v[208:223]
    v_cvt_pk_bf16_f32 v40, v30, v31
    v_exp_f32 v33, v87
    v_exp_f32 v28, v88
    v_cvt_pk_bf16_f32 v41, v32, v33
    v_exp_f32 v29, v89
    v_exp_f32 v30, v90
    v_cvt_pk_bf16_f32 v42, v28, v29
    v_exp_f32 v31, v91
    v_mfma_f32_32x32x16_bf16 v[76:91], v[168:171], v[56:59], 0
    v_cvt_pk_bf16_f32 v43, v30, v31
    v_exp_f32 v28, v60
    v_exp_f32 v29, v61
    v_exp_f32 v30, v62
    v_cvt_pk_bf16_f32 v36, v28, v29
    v_exp_f32 v31, v63
    v_exp_f32 v32, v64
    v_cvt_pk_bf16_f32 v37, v30, v31
    v_mfma_f32_32x32x16_bf16 v[208:223], v[176:179], v[40:43], v[208:223]
    v_exp_f32 v33, v65
    v_exp_f32 v28, v66
    v_cvt_pk_bf16_f32 v38, v32, v33
    v_exp_f32 v29, v67
    v_exp_f32 v30, v68
    v_cvt_pk_bf16_f32 v39, v28, v29
    v_exp_f32 v31, v69
    v_exp_f32 v32, v70
    v_mfma_f32_32x32x16_bf16 v[224:239], v[172:175], v[36:39], v[224:239]
    s_waitcnt vmcnt(12)
    v_cvt_pk_bf16_f32 v40, v30, v31
    v_exp_f32 v33, v71
    v_exp_f32 v28, v72
    v_cvt_pk_bf16_f32 v41, v32, v33
    v_exp_f32 v29, v73
    v_exp_f32 v30, v74
    v_cvt_pk_bf16_f32 v42, v28, v29
    v_exp_f32 v31, v75
    v_mfma_f32_32x32x16_bf16 v[60:75], v[180:183], v[44:47], 0
    v_cvt_pk_bf16_f32 v43, v30, v31
    v_exp_f32 v28, v76
    v_exp_f32 v29, v77
    v_exp_f32 v30, v78
    v_cvt_pk_bf16_f32 v36, v28, v29
    v_exp_f32 v31, v79
    v_exp_f32 v32, v80
    v_cvt_pk_bf16_f32 v37, v30, v31
    v_mfma_f32_32x32x16_bf16 v[224:239], v[176:179], v[40:43], v[224:239]
    v_exp_f32 v33, v81
    v_exp_f32 v28, v82
    v_cvt_pk_bf16_f32 v38, v32, v33
    v_exp_f32 v29, v83
    v_exp_f32 v30, v84
    v_cvt_pk_bf16_f32 v39, v28, v29
    v_exp_f32 v31, v85
    v_exp_f32 v32, v86
    v_mfma_f32_32x32x16_bf16 v[240:255], v[172:175], v[36:39], v[240:255]
    v_cvt_pk_bf16_f32 v40, v30, v31
    v_exp_f32 v33, v87
    v_exp_f32 v28, v88
    v_cvt_pk_bf16_f32 v41, v32, v33
    v_exp_f32 v29, v89
    v_exp_f32 v30, v90
    v_cvt_pk_bf16_f32 v42, v28, v29
    v_exp_f32 v31, v91
    v_mfma_f32_32x32x16_bf16 v[76:91], v[180:183], v[48:51], 0
    s_lshl_b32 s73, s73, 2
    s_andn2_b32 s72, s73, s74
    s_cbranch_scc1 fa_kvp4
fa_kvr4:
    v_cvt_pk_bf16_f32 v43, v30, v31
    v_exp_f32 v28, v60
    v_exp_f32 v29, v61
    v_exp_f32 v30, v62
    v_cvt_pk_bf16_f32 v36, v28, v29
    v_exp_f32 v31, v63
    v_exp_f32 v32, v64
    v_cvt_pk_bf16_f32 v37, v30, v31
    v_mfma_f32_32x32x16_bf16 v[240:255], v[176:179], v[40:43], v[240:255]
    buffer_load_dwordx4 v[168:171], v26, s[28:31], s67 offen sc1
    s_mov_b64 exec, s[68:69]
    buffer_load_dwordx4 v[172:175], v27, s[28:31], s67 offen sc1
    buffer_load_dwordx4 v[176:179], v27, s[28:31], s67 offen offset:512 sc1
    s_mov_b64 exec, -1
    v_exp_f32 v33, v65
    v_exp_f32 v28, v66
    v_cvt_pk_bf16_f32 v38, v32, v33
    v_exp_f32 v29, v67
    v_exp_f32 v30, v68
    v_cvt_pk_bf16_f32 v39, v28, v29
    v_exp_f32 v31, v69
    v_exp_f32 v32, v70
    v_mfma_f32_32x32x16_bf16 v[192:207], v[184:187], v[36:39], v[192:207]
    s_add_u32 s67, s67, 1024
    v_cvt_pk_bf16_f32 v40, v30, v31
    v_exp_f32 v33, v71
    v_exp_f32 v28, v72
    v_cvt_pk_bf16_f32 v41, v32, v33
    v_exp_f32 v29, v73
    v_exp_f32 v30, v74
    v_cvt_pk_bf16_f32 v42, v28, v29
    v_exp_f32 v31, v75
    v_mfma_f32_32x32x16_bf16 v[60:75], v[180:183], v[52:55], 0
    v_cvt_pk_bf16_f32 v43, v30, v31
    v_exp_f32 v28, v76
    v_exp_f32 v29, v77
    v_exp_f32 v30, v78
    v_cvt_pk_bf16_f32 v36, v28, v29
    v_exp_f32 v31, v79
    v_exp_f32 v32, v80
    v_cvt_pk_bf16_f32 v37, v30, v31
    v_mfma_f32_32x32x16_bf16 v[192:207], v[188:191], v[40:43], v[192:207]
    v_exp_f32 v33, v81
    v_exp_f32 v28, v82
    v_cvt_pk_bf16_f32 v38, v32, v33
    v_exp_f32 v29, v83
    v_exp_f32 v30, v84
    v_cvt_pk_bf16_f32 v39, v28, v29
    v_exp_f32 v31, v85
    v_exp_f32 v32, v86
    v_mfma_f32_32x32x16_bf16 v[208:223], v[184:187], v[36:39], v[208:223]
    v_cvt_pk_bf16_f32 v40, v30, v31
    v_exp_f32 v33, v87
    v_exp_f32 v28, v88
    v_cvt_pk_bf16_f32 v41, v32, v33
    v_exp_f32 v29, v89
    v_exp_f32 v30, v90
    v_cvt_pk_bf16_f32 v42, v28, v29
    v_exp_f32 v31, v91
    v_mfma_f32_32x32x16_bf16 v[76:91], v[180:183], v[56:59], 0
    v_cvt_pk_bf16_f32 v43, v30, v31
    v_exp_f32 v28, v60
    v_exp_f32 v29, v61
    v_exp_f32 v30, v62
    v_cvt_pk_bf16_f32 v36, v28, v29
    v_exp_f32 v31, v63
    v_exp_f32 v32, v64
    v_cvt_pk_bf16_f32 v37, v30, v31
    v_mfma_f32_32x32x16_bf16 v[208:223], v[188:191], v[40:43], v[208:223]
    v_exp_f32 v33, v65
    v_exp_f32 v28, v66
    v_cvt_pk_bf16_f32 v38, v32, v33
    v_exp_f32 v29, v67
    v_exp_f32 v30, v68
    v_cvt_pk_bf16_f32 v39, v28, v29
    v_exp_f32 v31, v69
    v_exp_f32 v32, v70
    v_mfma_f32_32x32x16_bf16 v[224:239], v[184:187], v[36:39], v[224:239]
    s_waitcnt vmcnt(12)
    v_cvt_pk_bf16_f32 v40, v30, v31
    v_exp_f32 v33, v71
    v_exp_f32 v28, v72
    v_cvt_pk_bf16_f32 v41, v32, v33
    v_exp_f32 v29, v73
    v_exp_f32 v30, v74
    v_cvt_pk_bf16_f32 v42, v28, v29
    v_exp_f32 v31, v75
    v_mfma_f32_32x32x16_bf16 v[60:75], v[120:123], v[44:47], 0
    v_cvt_pk_bf16_f32 v43, v30, v31
    v_exp_f32 v28, v76
    v_exp_f32 v29, v77
    v_exp_f32 v30, v78
    v_cvt_pk_bf16_f32 v36, v28, v29
    v_exp_f32 v31, v79
    v_exp_f32 v32, v80
    v_cvt_pk_bf16_f32 v37, v30, v31
    v_mfma_f32_32x32x16_bf16 v[224:239], v[188:191], v[40:43], v[224:239]
    v_exp_f32 v33, v81
    v_exp_f32 v28, v82
    v_cvt_pk_bf16_f32 v38, v32, v33
    v_exp_f32 v29, v83
    v_exp_f32 v30, v84
    v_cvt_pk_bf16_f32 v39, v28, v29
    v_exp_f32 v31, v85
    v_exp_f32 v32, v86
    v_mfma_f32_32x32x16_bf16 v[240:255], v[184:187], v[36:39], v[240:255]
    v_cvt_pk_bf16_f32 v40, v30, v31
    v_exp_f32 v33, v87
    v_exp_f32 v28, v88
    v_cvt_pk_bf16_f32 v41, v32, v33
    v_exp_f32 v29, v89
    v_exp_f32 v30, v90
    v_cvt_pk_bf16_f32 v42, v28, v29
    v_exp_f32 v31, v91
    v_mfma_f32_32x32x16_bf16 v[76:91], v[120:123], v[48:51], 0
    v_cvt_pk_bf16_f32 v43, v30, v31
    v_exp_f32 v28, v60
    v_exp_f32 v29, v61
    v_exp_f32 v30, v62
    v_cvt_pk_bf16_f32 v36, v28, v29
    v_exp_f32 v31, v63
    v_exp_f32 v32, v64
    v_cvt_pk_bf16_f32 v37, v30, v31
    v_mfma_f32_32x32x16_bf16 v[240:255], v[188:191], v[40:43], v[240:255]
    buffer_load_dwordx4 v[180:183], v26, s[28:31], s67 offen sc1
    s_mov_b64 exec, s[68:69]
    buffer_load_dwordx4 v[184:187], v27, s[28:31], s67 offen sc1
    buffer_load_dwordx4 v[188:191], v27, s[28:31], s67 offen offset:512 sc1
    s_mov_b64 exec, -1
    v_exp_f32 v33, v65
    v_exp_f32 v28, v66
    v_cvt_pk_bf16_f32 v38, v32, v33
    v_exp_f32 v29, v67
    v_exp_f32 v30, v68
    v_cvt_pk_bf16_f32 v39, v28, v29
    v_exp_f32 v31, v69
    v_exp_f32 v32, v70
    v_mfma_f32_32x32x16_bf16 v[192:207], v[124:127], v[36:39], v[192:207]
    s_add_u32 s67, s67, 3072
    v_cvt_pk_bf16_f32 v40, v30, v31
    v_exp_f32 v33, v71
    v_exp_f32 v28, v72
    v_cvt_pk_bf16_f32 v41, v32, v33
    v_exp_f32 v29, v73
    v_exp_f32 v30, v74
    v_cvt_pk_bf16_f32 v42, v28, v29
    v_exp_f32 v31, v75
    v_mfma_f32_32x32x16_bf16 v[60:75], v[120:123], v[52:55], 0
    s_and_b32 s67, s67, 0xffff
    v_cvt_pk_bf16_f32 v43, v30, v31
    v_exp_f32 v28, v76
    v_exp_f32 v29, v77
    v_exp_f32 v30, v78
    v_cvt_pk_bf16_f32 v36, v28, v29
    v_exp_f32 v31, v79
    v_exp_f32 v32, v80
    v_cvt_pk_bf16_f32 v37, v30, v31
    v_mfma_f32_32x32x16_bf16 v[192:207], v[128:131], v[40:43], v[192:207]
    v_exp_f32 v33, v81
    v_exp_f32 v28, v82
    v_cvt_pk_bf16_f32 v38, v32, v33
    v_exp_f32 v29, v83
    v_exp_f32 v30, v84
    v_cvt_pk_bf16_f32 v39, v28, v29
    v_exp_f32 v31, v85
    v_exp_f32 v32, v86
    v_mfma_f32_32x32x16_bf16 v[208:223], v[124:127], v[36:39], v[208:223]
    v_cvt_pk_bf16_f32 v40, v30, v31
    v_exp_f32 v33, v87
    v_exp_f32 v28, v88
    v_cvt_pk_bf16_f32 v41, v32, v33
    v_exp_f32 v29, v89
    v_exp_f32 v30, v90
    v_cvt_pk_bf16_f32 v42, v28, v29
    v_exp_f32 v31, v91
    v_mfma_f32_32x32x16_bf16 v[76:91], v[120:123], v[56:59], 0
    v_cvt_pk_bf16_f32 v43, v30, v31
    v_exp_f32 v28, v60
    v_exp_f32 v29, v61
    v_exp_f32 v30, v62
    v_cvt_pk_bf16_f32 v36, v28, v29
    v_exp_f32 v31, v63
    v_exp_f32 v32, v64
    v_cvt_pk_bf16_f32 v37, v30, v31
    v_mfma_f32_32x32x16_bf16 v[208:223], v[128:131], v[40:43], v[208:223]
    v_exp_f32 v33, v65
    v_exp_f32 v28, v66
    v_cvt_pk_bf16_f32 v38, v32, v33
    v_exp_f32 v29, v67
    v_exp_f32 v30, v68
    v_cvt_pk_bf16_f32 v39, v28, v29
    v_exp_f32 v31, v69
    v_exp_f32 v32, v70
    v_mfma_f32_32x32x16_bf16 v[224:239], v[124:127], v[36:39], v[224:239]
    s_waitcnt vmcnt(12)
    v_cvt_pk_bf16_f32 v40, v30, v31
    v_exp_f32 v33, v71
    v_exp_f32 v28, v72
    v_cvt_pk_bf16_f32 v41, v32, v33
    v_exp_f32 v29, v73
    v_exp_f32 v30, v74
    v_cvt_pk_bf16_f32 v42, v28, v29
    v_exp_f32 v31, v75
    v_mfma_f32_32x32x16_bf16 v[60:75], v[132:135], v[44:47], 0
    v_cvt_pk_bf16_f32 v43, v30, v31
    v_exp_f32 v28, v76
    v_exp_f32 v29, v77
    v_exp_f32 v30, v78
    v_cvt_pk_bf16_f32 v36, v28, v29
    v_exp_f32 v31, v79
    v_exp_f32 v32, v80
    v_cvt_pk_bf16_f32 v37, v30, v31
    v_mfma_f32_32x32x16_bf16 v[224:239], v[128:131], v[40:43], v[224:239]
    v_exp_f32 v33, v81
    v_exp_f32 v28, v82
    v_cvt_pk_bf16_f32 v38, v32, v33
    v_exp_f32 v29, v83
    v_exp_f32 v30, v84
    v_cvt_pk_bf16_f32 v39, v28, v29
    v_exp_f32 v31, v85
    v_exp_f32 v32, v86
    v_mfma_f32_32x32x16_bf16 v[240:255], v[124:127], v[36:39], v[240:255]
    v_cvt_pk_bf16_f32 v40, v30, v31
    v_exp_f32 v33, v87
    v_exp_f32 v28, v88
    v_cvt_pk_bf16_f32 v41, v32, v33
    v_exp_f32 v29, v89
    v_exp_f32 v30, v90
    v_cvt_pk_bf16_f32 v42, v28, v29
    v_exp_f32 v31, v91
    v_mfma_f32_32x32x16_bf16 v[76:91], v[132:135], v[48:51], 0
    s_lshl_b32 s73, s73, 2
    s_andn2_b32 s72, s73, s74
    s_cbranch_scc1 fa_kvp5
fa_kvr5:
    v_cvt_pk_bf16_f32 v43, v30, v31
    v_exp_f32 v28, v60
    v_exp_f32 v29, v61
    v_exp_f32 v30, v62
    v_cvt_pk_bf16_f32 v36, v28, v29
    v_exp_f32 v31, v63
    v_exp_f32 v32, v64
    v_cvt_pk_bf16_f32 v37, v30, v31
    v_mfma_f32_32x32x16_bf16 v[240:255], v[128:131], v[40:43], v[240:255]
    buffer_load_dwordx4 v[120:123], v26, s[28:31], s67 offen sc1
    s_mov_b64 exec, s[68:69]
    buffer_load_dwordx4 v[124:127], v27, s[28:31], s67 offen sc1
    buffer_load_dwordx4 v[128:131], v27, s[28:31], s67 offen offset:512 sc1
    s_mov_b64 exec, -1
    v_exp_f32 v33, v65
    v_exp_f32 v28, v66
    v_cvt_pk_bf16_f32 v38, v32, v33
    v_exp_f32 v29, v67
    v_exp_f32 v30, v68
    v_cvt_pk_bf16_f32 v39, v28, v29
    v_exp_f32 v31, v69
    v_exp_f32 v32, v70
    v_mfma_f32_32x32x16_bf16 v[192:207], v[136:139], v[36:39], v[192:207]
    s_add_u32 s67, s67, 1024
    v_cvt_pk_bf16_f32 v40, v30, v31
    v_exp_f32 v33, v71
    v_exp_f32 v28, v72
    v_cvt_pk_bf16_f32 v41, v32, v33
    v_exp_f32 v29, v73
    v_exp_f32 v30, v74
    v_cvt_pk_bf16_f32 v42, v28, v29
    v_exp_f32 v31, v75
    v_mfma_f32_32x32x16_bf16 v[60:75], v[132:135], v[52:55], 0
    v_cvt_pk_bf16_f32 v43, v30, v31
    v_exp_f32 v28, v76
    v_exp_f32 v29, v77
    v_exp_f32 v30, v78
    v_cvt_pk_bf16_f32 v36, v28, v29
    v_exp_f32 v31, v79
    v_exp_f32 v32, v80
    v_cvt_pk_bf16_f32 v37, v30, v31
    v_mfma_f32_32x32x16_bf16 v[192:207], v[140:143], v[40:43], v[192:207]
    v_exp_f32 v33, v81
    v_exp_f32 v28, v82
    v_cvt_pk_bf16_f32 v38, v32, v33
    v_exp_f32 v29, v83
    v_exp_f32 v30, v84
    v_cvt_pk_bf16_f32 v39, v28, v29
    v_exp_f32 v31, v85
    v_exp_f32 v32, v86
    v_mfma_f32_32x32x16_bf16 v[208:223], v[136:139], v[36:39], v[208:223]
    v_cvt_pk_bf16_f32 v40, v30, v31
    v_exp_f32 v33, v87
    v_exp_f32 v28, v88
    v_cvt_pk_bf16_f32 v41, v32, v33
    v_exp_f32 v29, v89
    v_exp_f32 v30, v90
    v_cvt_pk_bf16_f32 v42, v28, v29
    v_exp_f32 v31, v91
    v_mfma_f32_32x32x16_bf16 v[76:91], v[132:135], v[56:59], 0
    v_cvt_pk_bf16_f32 v43, v30, v31
    v_exp_f32 v28, v60
    v_exp_f32 v29, v61
    v_exp_f32 v30, v62
    v_cvt_pk_bf16_f32 v36, v28, v29
    v_exp_f32 v31, v63
    v_exp_f32 v32, v64
    v_cvt_pk_bf16_f32 v37, v30, v31
    v_mfma_f32_32x32x16_bf16 v[208:223], v[140:143], v[40:43], v[208:223]
    v_exp_f32 v33, v65
    v_exp_f32 v28, v66
    v_cvt_pk_bf16_f32 v38, v32, v33
    v_exp_f32 v29, v67
    v_exp_f32 v30, v68
    v_cvt_pk_bf16_f32 v39, v28, v29
    v_exp_f32 v31, v69
    v_exp_f32 v32, v70
    v_mfma_f32_32x32x16_bf16 v[224:239], v[136:139], v[36:39], v[224:239]
    s_waitcnt vmcnt(12)
    v_cvt_pk_bf16_f32 v40, v30, v31
    v_exp_f32 v33, v71
    v_exp_f32 v28, v72
    v_cvt_pk_bf16_f32 v41, v32, v33
    v_exp_f32 v29, v73
    v_exp_f32 v30, v74
    v_cvt_pk_bf16_f32 v42, v28, v29
    v_exp_f32 v31, v75
    v_mfma_f32_32x32x16_bf16 v[60:75], v[144:147], v[44:47], 0
    v_cvt_pk_bf16_f32 v43, v30, v31
    v_exp_f32 v28, v76
    v_exp_f32 v29, v77
    v_exp_f32 v30, v78
    v_cvt_pk_bf16_f32 v36, v28, v29
    v_exp_f32 v31, v79
    v_exp_f32 v32, v80
    v_cvt_pk_bf16_f32 v37, v30, v31
    v_mfma_f32_32x32x16_bf16 v[224:239], v[140:143], v[40:43], v[224:239]
    s_sub_u32 s51, s51, 1
    v_exp_f32 v33, v81
    v_exp_f32 v28, v82
    v_cvt_pk_bf16_f32 v38, v32, v33
    v_exp_f32 v29, v83
    v_exp_f32 v30, v84
    v_cvt_pk_bf16_f32 v39, v28, v29
    v_exp_f32 v31, v85
    v_exp_f32 v32, v86
    v_mfma_f32_32x32x16_bf16 v[240:255], v[136:139], v[36:39], v[240:255]
    s_cmp_lg_u32 s51, 0
    v_cvt_pk_bf16_f32 v40, v30, v31
    v_exp_f32 v33, v87
    v_exp_f32 v28, v88
    v_cvt_pk_bf16_f32 v41, v32, v33
    v_exp_f32 v29, v89
    v_exp_f32 v30, v90
    v_cvt_pk_bf16_f32 v42, v28, v29
    v_exp_f32 v31, v91
    s_cbranch_scc1 fa_loop
    v_cvt_pk_bf16_f32 v43, v30, v31
    s_nop 1
    v_mfma_f32_32x32x16_bf16 v[240:255], v[140:143], v[40:43], v[240:255]
    s_mul_i32 s47, s3, 4608
    s_add_u32 s47, s47, 110592
    v_add_u32 v5, s47, v24
    v_lshl_add_u32 v6, v1, 2, s47
    ds_write_b128 v5, v[192:195] offset:0
    ds_write_b128 v5, v[196:199] offset:1024
    ds_write_b32 v6, v200 offset:2048
    ds_write_b128 v5, v[208:211] offset:2304
    ds_write_b128 v5, v[212:215] offset:3328
    ds_write_b32 v6, v216 offset:4352
    s_xor_b32 s47, s3, 2
    s_mul_i32 s47, s47, 4608
    s_add_u32 s47, s47, 110592
    v_add_u32 v7, s47, v24
    v_lshl_add_u32 v8, v1, 2, s47
    s_mov_b32 s72, 0x21800000
    s_mov_b32 s73, 0x5d800000
    s_lshl_b32 s76, s44, 1
    s_add_u32 s76, s76, s71
    s_lshl_b32 s76, s76, 6
    s_add_u32 s76, s76, s70
    s_lshl_b32 s76, s76, 10
    s_add_u32 s76, s76, 8388608
    s_add_u32 s77, s76, 32768
    s_waitcnt lgkmcnt(0)
    s_barrier
    ds_read_b128 v[60:63], v7 offset:0
    ds_read_b128 v[64:67], v7 offset:1024
    ds_read_b32 v68, v8 offset:2048
    ds_read_b128 v[72:75], v7 offset:2304
    ds_read_b128 v[76:79], v7 offset:3328
    ds_read_b32 v80, v8 offset:4352
    s_waitcnt lgkmcnt(3)
    v_add_f32 v224, v224, v60
    v_add_f32 v225, v225, v61
    v_add_f32 v226, v226, v62
    v_add_f32 v227, v227, v63
    v_add_f32 v228, v228, v64
    v_add_f32 v229, v229, v65
    v_add_f32 v230, v230, v66
    v_add_f32 v231, v231, v67
    v_add_f32 v232, v232, v68
    s_waitcnt lgkmcnt(0)
    v_add_f32 v240, v240, v72
    v_add_f32 v241, v241, v73
    v_add_f32 v242, v242, v74
    v_add_f32 v243, v243, v75
    v_add_f32 v244, v244, v76
    v_add_f32 v245, v245, v77
    v_add_f32 v246, v246, v78
    v_add_f32 v247, v247, v79
    v_add_f32 v248, v248, v80
    v_max3_f32 v2, |v224|, |v225|, |v232|
    v_max3_f32 v2, v2, |v226|, |v227|
    v_max3_f32 v2, v2, |v228|, |v229|
    v_max3_f32 v2, v2, |v230|, |v231|
    v_add_f32 v3, v224, v225
    v_add_f32 v4, v226, v227
    v_add_f32 v3, v3, v4
    v_add_f32 v4, v228, v229
    v_add_f32 v3, v3, v4
    v_add_f32 v4, v230, v231
    v_add_f32 v3, v3, v4
    v_cmp_nge_f32 vcc, s73, v2
    v_cmp_nle_f32 s[74:75], s72, v232
    s_or_b64 vcc, vcc, s[74:75]
    v_cmp_u_f32 s[74:75], v3, v3
    s_or_b64 vcc, vcc, s[74:75]
    s_cbranch_vccnz fa_fb0
fa_ok0:
    v_rcp_f32 v232, v232
    s_nop 0
    v_mul_f32 v224, v224, v232
    v_mul_f32 v225, v225, v232
    v_mul_f32 v226, v226, v232
    v_mul_f32 v227, v227, v232
    v_mul_f32 v228, v228, v232
    v_mul_f32 v229, v229, v232
    v_mul_f32 v230, v230, v232
    v_mul_f32 v231, v231, v232
    v_cvt_pk_bf16_f32 v224, v224, v225
    v_cvt_pk_bf16_f32 v225, v226, v227
    v_cvt_pk_bf16_f32 v226, v228, v229
    v_cvt_pk_bf16_f32 v227, v230, v231
    buffer_store_dwordx4 v[224:227], v24, s[28:31], s76 offen sc1
    v_max3_f32 v2, |v240|, |v241|, |v248|
    v_max3_f32 v2, v2, |v242|, |v243|
    v_max3_f32 v2, v2, |v244|, |v245|
    v_max3_f32 v2, v2, |v246|, |v247|
    v_add_f32 v3, v240, v241
    v_add_f32 v4, v242, v243
    v_add_f32 v3, v3, v4
    v_add_f32 v4, v244, v245
    v_add_f32 v3, v3, v4
    v_add_f32 v4, v246, v247
    v_add_f32 v3, v3, v4
    v_cmp_nge_f32 vcc, s73, v2
    v_cmp_nle_f32 s[74:75], s72, v248
    s_or_b64 vcc, vcc, s[74:75]
    v_cmp_u_f32 s[74:75], v3, v3
    s_or_b64 vcc, vcc, s[74:75]
    s_cbranch_vccnz fa_fb1
fa_ok1:
    v_rcp_f32 v248, v248
    s_nop 0
    v_mul_f32 v240, v240, v248
    v_mul_f32 v241, v241, v248
    v_mul_f32 v242, v242, v248
    v_mul_f32 v243, v243, v248
    v_mul_f32 v244, v244, v248
    v_mul_f32 v245, v245, v248
    v_mul_f32 v246, v246, v248
    v_mul_f32 v247, v247, v248
    v_cvt_pk_bf16_f32 v240, v240, v241
    v_cvt_pk_bf16_f32 v241, v242, v243
    v_cvt_pk_bf16_f32 v242, v244, v245
    v_cvt_pk_bf16_f32 v243, v246, v247
    buffer_store_dwordx4 v[240:243], v24, s[28:31], s77 offen sc1
    s_waitcnt vmcnt(0)
    s_lshl_b32 s47, s3, 2
    s_add_u32 s47, s47, s52
    v_mov_b32 v2, 0
    v_mov_b32 v3, 1
    s_mov_b64 exec, 1
    buffer_store_dword v3, v2, s[28:31], s47 offen offset:32 sc1
    s_mov_b64 exec, -1
    s_endpgm
fa_kvp0:
    buffer_load_dword v14, v13, s[28:31], 0 offen sc1
    s_waitcnt vmcnt(0)
    v_cmp_eq_u32 vcc, 1, v14
    s_sub_u32 s75, s75, 1
    s_cselect_b32 s73, 0, s73
    s_mov_b32 s74, vcc_lo
    s_andn2_b32 s72, s73, s74
    s_cbranch_scc1 fa_kvp0
    s_branch fa_kvr0
fa_kvp1:
    buffer_load_dword v14, v13, s[28:31], 0 offen sc1
    s_waitcnt vmcnt(0)
    v_cmp_eq_u32 vcc, 1, v14
    s_sub_u32 s75, s75, 1
    s_cselect_b32 s73, 0, s73
    s_mov_b32 s74, vcc_lo
    s_andn2_b32 s72, s73, s74
    s_cbranch_scc1 fa_kvp1
    s_branch fa_kvr1
fa_kvp2:
    buffer_load_dword v14, v13, s[28:31], 0 offen sc1
    s_waitcnt vmcnt(0)
    v_cmp_eq_u32 vcc, 1, v14
    s_sub_u32 s75, s75, 1
    s_cselect_b32 s73, 0, s73
    s_mov_b32 s74, vcc_lo
    s_andn2_b32 s72, s73, s74
    s_cbranch_scc1 fa_kvp2
    s_branch fa_kvr2
fa_kvp3:
    buffer_load_dword v14, v13, s[28:31], 0 offen sc1
    s_waitcnt vmcnt(0)
    v_cmp_eq_u32 vcc, 1, v14
    s_sub_u32 s75, s75, 1
    s_cselect_b32 s73, 0, s73
    s_mov_b32 s74, vcc_lo
    s_andn2_b32 s72, s73, s74
    s_cbranch_scc1 fa_kvp3
    s_branch fa_kvr3
fa_kvp4:
    buffer_load_dword v14, v13, s[28:31], 0 offen sc1
    s_waitcnt vmcnt(0)
    v_cmp_eq_u32 vcc, 1, v14
    s_sub_u32 s75, s75, 1
    s_cselect_b32 s73, 0, s73
    s_mov_b32 s74, vcc_lo
    s_andn2_b32 s72, s73, s74
    s_cbranch_scc1 fa_kvp4
    s_branch fa_kvr4
fa_kvp5:
    buffer_load_dword v14, v13, s[28:31], 0 offen sc1
    s_waitcnt vmcnt(0)
    v_cmp_eq_u32 vcc, 1, v14
    s_sub_u32 s75, s75, 1
    s_cselect_b32 s73, 0, s73
    s_mov_b32 s74, vcc_lo
    s_andn2_b32 s72, s73, s74
    s_cbranch_scc1 fa_kvp5
    s_branch fa_kvr5
fa_fb0:
    s_waitcnt vmcnt(0)
    s_mov_b32 s78, 0
    v_mov_b32 v172, 0xff7fffff
fa_fb_max0:
    buffer_load_dwordx4 v[120:123], v26, s[28:31], s78 offen sc1
    s_waitcnt vmcnt(0)
    v_mfma_f32_32x32x16_bf16 v[132:147], v[120:123], v[52:55], 0
    s_add_u32 s78, s78, 1024
    s_cmp_lg_u32 s78, 0x10000
    s_nop 9
    v_max3_f32 v172, v172, v132, v133
    v_max3_f32 v172, v172, v134, v135
    v_max3_f32 v172, v172, v136, v137
    v_max3_f32 v172, v172, v138, v139
    v_max3_f32 v172, v172, v140, v141
    v_max3_f32 v172, v172, v142, v143
    v_max3_f32 v172, v172, v144, v145
    v_max3_f32 v172, v172, v146, v147
    s_cbranch_scc1 fa_fb_max0
    v_mov_b32 v173, v172
    s_nop 1
    v_permlane32_swap_b32 v172, v173
    v_max_f32 v172, v172, v173
    s_mov_b32 s78, 0
    v_mov_b32 v148, 0
    v_mov_b32 v149, 0
    v_mov_b32 v150, 0
    v_mov_b32 v151, 0
    v_mov_b32 v152, 0
    v_mov_b32 v153, 0
    v_mov_b32 v154, 0
    v_mov_b32 v155, 0
    v_mov_b32 v156, 0
    v_mov_b32 v157, 0
    v_mov_b32 v158, 0
    v_mov_b32 v159, 0
    v_mov_b32 v160, 0
    v_mov_b32 v161, 0
    v_mov_b32 v162, 0
    v_mov_b32 v163, 0
    v_mov_b32 v124, 0x3f803f80
    v_mov_b32 v125, 0x3f803f80
    v_mov_b32 v126, 0x3f803f80
    v_mov_b32 v127, 0x3f803f80
    v_mov_b32 v128, 0x3f803f80
    v_mov_b32 v129, 0x3f803f80
    v_mov_b32 v130, 0x3f803f80
    v_mov_b32 v131, 0x3f803f80
fa_fb_pv0:
    buffer_load_dwordx4 v[120:123], v26, s[28:31], s78 offen sc1
    s_mov_b64 exec, s[68:69]
    buffer_load_dwordx4 v[124:127], v27, s[28:31], s78 offen sc1
    buffer_load_dwordx4 v[128:131], v27, s[28:31], s78 offen offset:512 sc1
    s_mov_b64 exec, -1
    s_waitcnt vmcnt(0)
    v_mfma_f32_32x32x16_bf16 v[132:147], v[120:123], v[52:55], 0
    s_add_u32 s78, s78, 1024
    s_cmp_lg_u32 s78, 0x10000
    s_nop 9
    v_sub_f32 v132, v132, v172
    v_sub_f32 v133, v133, v172
    v_sub_f32 v134, v134, v172
    v_sub_f32 v135, v135, v172
    v_sub_f32 v136, v136, v172
    v_sub_f32 v137, v137, v172
    v_sub_f32 v138, v138, v172
    v_sub_f32 v139, v139, v172
    v_sub_f32 v140, v140, v172
    v_sub_f32 v141, v141, v172
    v_sub_f32 v142, v142, v172
    v_sub_f32 v143, v143, v172
    v_sub_f32 v144, v144, v172
    v_sub_f32 v145, v145, v172
    v_sub_f32 v146, v146, v172
    v_sub_f32 v147, v147, v172
    v_exp_f32 v132, v132
    v_exp_f32 v133, v133
    v_exp_f32 v134, v134
    v_exp_f32 v135, v135
    v_exp_f32 v136, v136
    v_exp_f32 v137, v137
    v_exp_f32 v138, v138
    v_exp_f32 v139, v139
    v_exp_f32 v140, v140
    v_exp_f32 v141, v141
    v_exp_f32 v142, v142
    v_exp_f32 v143, v143
    v_exp_f32 v144, v144
    v_exp_f32 v145, v145
    v_exp_f32 v146, v146
    v_exp_f32 v147, v147
    v_cvt_pk_bf16_f32 v164, v132, v133
    v_cvt_pk_bf16_f32 v165, v134, v135
    v_cvt_pk_bf16_f32 v166, v136, v137
    v_cvt_pk_bf16_f32 v167, v138, v139
    v_cvt_pk_bf16_f32 v168, v140, v141
    v_cvt_pk_bf16_f32 v169, v142, v143
    v_cvt_pk_bf16_f32 v170, v144, v145
    v_cvt_pk_bf16_f32 v171, v146, v147
    v_mfma_f32_32x32x16_bf16 v[148:163], v[124:127], v[164:167], v[148:163]
    s_nop 0
    v_mfma_f32_32x32x16_bf16 v[148:163], v[128:131], v[168:171], v[148:163]
    s_nop 7
    s_cbranch_scc1 fa_fb_pv0
    s_nop 2
    v_mov_b32 v224, v148
    v_mov_b32 v225, v149
    v_mov_b32 v226, v150
    v_mov_b32 v227, v151
    v_mov_b32 v228, v152
    v_mov_b32 v229, v153
    v_mov_b32 v230, v154
    v_mov_b32 v231, v155
    v_mov_b32 v232, v156
    s_nop 1
    s_branch fa_ok0
fa_fb1:
    s_waitcnt vmcnt(0)
    s_mov_b32 s78, 0
    v_mov_b32 v172, 0xff7fffff
fa_fb_max1:
    buffer_load_dwordx4 v[120:123], v26, s[28:31], s78 offen sc1
    s_waitcnt vmcnt(0)
    v_mfma_f32_32x32x16_bf16 v[132:147], v[120:123], v[56:59], 0
    s_add_u32 s78, s78, 1024
    s_cmp_lg_u32 s78, 0x10000
    s_nop 9
    v_max3_f32 v172, v172, v132, v133
    v_max3_f32 v172, v172, v134, v135
    v_max3_f32 v172, v172, v136, v137
    v_max3_f32 v172, v172, v138, v139
    v_max3_f32 v172, v172, v140, v141
    v_max3_f32 v172, v172, v142, v143
    v_max3_f32 v172, v172, v144, v145
    v_max3_f32 v172, v172, v146, v147
    s_cbranch_scc1 fa_fb_max1
    v_mov_b32 v173, v172
    s_nop 1
    v_permlane32_swap_b32 v172, v173
    v_max_f32 v172, v172, v173
    s_mov_b32 s78, 0
    v_mov_b32 v148, 0
    v_mov_b32 v149, 0
    v_mov_b32 v150, 0
    v_mov_b32 v151, 0
    v_mov_b32 v152, 0
    v_mov_b32 v153, 0
    v_mov_b32 v154, 0
    v_mov_b32 v155, 0
    v_mov_b32 v156, 0
    v_mov_b32 v157, 0
    v_mov_b32 v158, 0
    v_mov_b32 v159, 0
    v_mov_b32 v160, 0
    v_mov_b32 v161, 0
    v_mov_b32 v162, 0
    v_mov_b32 v163, 0
    v_mov_b32 v124, 0x3f803f80
    v_mov_b32 v125, 0x3f803f80
    v_mov_b32 v126, 0x3f803f80
    v_mov_b32 v127, 0x3f803f80
    v_mov_b32 v128, 0x3f803f80
    v_mov_b32 v129, 0x3f803f80
    v_mov_b32 v130, 0x3f803f80
    v_mov_b32 v131, 0x3f803f80
fa_fb_pv1:
    buffer_load_dwordx4 v[120:123], v26, s[28:31], s78 offen sc1
    s_mov_b64 exec, s[68:69]
    buffer_load_dwordx4 v[124:127], v27, s[28:31], s78 offen sc1
    buffer_load_dwordx4 v[128:131], v27, s[28:31], s78 offen offset:512 sc1
    s_mov_b64 exec, -1
    s_waitcnt vmcnt(0)
    v_mfma_f32_32x32x16_bf16 v[132:147], v[120:123], v[56:59], 0
    s_add_u32 s78, s78, 1024
    s_cmp_lg_u32 s78, 0x10000
    s_nop 9
    v_sub_f32 v132, v132, v172
    v_sub_f32 v133, v133, v172
    v_sub_f32 v134, v134, v172
    v_sub_f32 v135, v135, v172
    v_sub_f32 v136, v136, v172
    v_sub_f32 v137, v137, v172
    v_sub_f32 v138, v138, v172
    v_sub_f32 v139, v139, v172
    v_sub_f32 v140, v140, v172
    v_sub_f32 v141, v141, v172
    v_sub_f32 v142, v142, v172
    v_sub_f32 v143, v143, v172
    v_sub_f32 v144, v144, v172
    v_sub_f32 v145, v145, v172
    v_sub_f32 v146, v146, v172
    v_sub_f32 v147, v147, v172
    v_exp_f32 v132, v132
    v_exp_f32 v133, v133
    v_exp_f32 v134, v134
    v_exp_f32 v135, v135
    v_exp_f32 v136, v136
    v_exp_f32 v137, v137
    v_exp_f32 v138, v138
    v_exp_f32 v139, v139
    v_exp_f32 v140, v140
    v_exp_f32 v141, v141
    v_exp_f32 v142, v142
    v_exp_f32 v143, v143
    v_exp_f32 v144, v144
    v_exp_f32 v145, v145
    v_exp_f32 v146, v146
    v_exp_f32 v147, v147
    v_cvt_pk_bf16_f32 v164, v132, v133
    v_cvt_pk_bf16_f32 v165, v134, v135
    v_cvt_pk_bf16_f32 v166, v136, v137
    v_cvt_pk_bf16_f32 v167, v138, v139
    v_cvt_pk_bf16_f32 v168, v140, v141
    v_cvt_pk_bf16_f32 v169, v142, v143
    v_cvt_pk_bf16_f32 v170, v144, v145
    v_cvt_pk_bf16_f32 v171, v146, v147
    v_mfma_f32_32x32x16_bf16 v[148:163], v[124:127], v[164:167], v[148:163]
    s_nop 0
    v_mfma_f32_32x32x16_bf16 v[148:163], v[128:131], v[168:171], v[148:163]
    s_nop 7
    s_cbranch_scc1 fa_fb_pv1
    s_nop 2
    v_mov_b32 v240, v148
    v_mov_b32 v241, v149
    v_mov_b32 v242, v150
    v_mov_b32 v243, v151
    v_mov_b32 v244, v152
    v_mov_b32 v245, v153
    v_mov_b32 v246, v154
    v_mov_b32 v247, v155
    v_mov_b32 v248, v156
    s_nop 1
    s_branch fa_ok1
fz_role_b:
    s_add_u32 s47, s46, 4
    s_and_b32 s47, s47, 7
    s_lshl_b32 s47, s47, 7
    s_add_u32 s54, s48, s47
    s_add_u32 s47, s46, 5
    s_and_b32 s47, s47, 7
    s_lshl_b32 s47, s47, 7
    s_add_u32 s55, s48, s47
    s_add_u32 s47, s46, 6
    s_and_b32 s47, s47, 7
    s_lshl_b32 s47, s47, 7
    s_add_u32 s56, s48, s47
    s_add_u32 s47, s46, 7
    s_and_b32 s47, s47, 7
    s_lshl_b32 s47, s47, 7
    s_add_u32 s57, s48, s47
    v_lshrrev_b32 v2, 4, v1
    v_and_b32 v3, 7, v1
    v_xor_b32 v2, v2, v3
    v_lshlrev_b32 v2, 4, v2
    v_lshrrev_b32 v3, 3, v1
    v_lshl_add_u32 v32, v3, 10, v2
    v_xor_b32 v33, 64, v32
    v_add_u32 v34, 14336, v32
    v_add_u32 v35, 21504, v33
    v_add_u32 v33, 7168, v33
    s_waitcnt lgkmcnt(0)
    s_mov_b32 s24, s4
    s_mov_b32 s25, s5
    s_mov_b32 s26, 2097152
    s_mov_b32 s27, 0x20000
    s_add_u32 m0, s50, 0
    s_nop 0
    buffer_load_dwordx4 v32, s[24:27], s54 offen offset:0 lds
    buffer_load_dwordx4 v33, s[24:27], s54 offen offset:1024 lds
    buffer_load_dwordx4 v34, s[24:27], s54 offen offset:2048 lds
    buffer_load_dwordx4 v35, s[24:27], s54 offen offset:3072 lds
    s_add_u32 m0, s50, 4096
    s_nop 0
    buffer_load_dwordx4 v32, s[24:27], s55 offen offset:0 lds
    buffer_load_dwordx4 v33, s[24:27], s55 offen offset:1024 lds
    buffer_load_dwordx4 v34, s[24:27], s55 offen offset:2048 lds
    buffer_load_dwordx4 v35, s[24:27], s55 offen offset:3072 lds
    s_mov_b32 s28, s22
    s_mov_b32 s29, s23
    s_mov_b32 s30, 33554432
    s_mov_b32 s31, 0x20000
    s_mov_b32 s32, s12
    s_mov_b32 s33, s13
    s_mov_b32 s34, 1409024
    s_mov_b32 s35, 0x20000
    s_mov_b32 s36, s14
    s_mov_b32 s37, s15
    s_mov_b32 s38, 1409024
    s_mov_b32 s39, 0x20000
    s_mov_b32 s40, s18
    s_mov_b32 s41, s19
    s_mov_b32 s42, 2097152
    s_mov_b32 s43, 0x20000
    v_and_b32 v2, 31, v1
    v_lshrrev_b32 v3, 5, v1
    v_bfe_u32 v4, v1, 1, 3
    v_xor_b32 v3, v3, v4
    v_lshlrev_b32 v3, 4, v3
    v_lshl_add_u32 v2, v2, 7, v3
    v_add_u32 v36, s50, v2
    v_xor_b32 v37, 32, v36
    v_xor_b32 v38, 64, v36
    v_xor_b32 v39, 96, v36
    v_and_b32 v10, 7, v1
    v_lshlrev_b32 v10, 2, v10
    v_add_u32 v10, 160256, v10
    v_mov_b32 v2, 0
    ds_write_b32 v10, v2
    v_lshlrev_b32 v11, 4, v1
    v_add_u32 v46, s50, v11
    s_mul_i32 s66, s3, 3072
    s_mul_i32 s47, s3, 44032
    s_mul_i32 s48, s45, 192
    s_add_u32 s47, s47, s48
    v_add_u32 v2, 0, v1
    v_mul_u32_u24 v3, 21846, v2
    v_lshrrev_b32 v3, 18, v3
    v_mul_u32_u24 v4, 2560, v3
    v_lshl_add_u32 v4, v1, 4, v4
    v_add_u32 v5, s47, v4
    v_add_u32 v2, 64, v1
    v_mul_u32_u24 v3, 21846, v2
    v_lshrrev_b32 v3, 18, v3
    v_mul_u32_u24 v4, 2560, v3
    v_lshl_add_u32 v4, v1, 4, v4
    v_add_u32 v6, s47, v4
    v_add_u32 v2, 128, v1
    v_mul_u32_u24 v3, 21846, v2
    v_lshrrev_b32 v3, 18, v3
    v_mul_u32_u24 v4, 2560, v3
    v_lshl_add_u32 v4, v1, 4, v4
    v_add_u32 v7, s47, v4
    v_lshrrev_b32 v2, 5, v1
    v_lshlrev_b32 v2, 3, v2
    v_bfe_u32 v3, v1, 2, 2
    v_add_u32 v2, v2, v3
    v_mul_u32_u24 v2, 192, v2
    v_bfe_u32 v3, v1, 4, 1
    v_mul_u32_u24 v3, 12320, v3
    v_add_u32 v2, v2, v3
    v_and_b32 v3, 3, v1
    v_lshl_add_u32 v2, v3, 3, v2
    v_add_u32 v8, 131072, v2
    v_add_u32 v9, 59392, v2
    v_mov_b32 v0, v2
    s_add_u32 s47, s46, 0
    s_and_b32 s47, s47, 7
    s_mul_i32 s58, s47, 176128
    s_add_u32 s47, s46, 1
    s_and_b32 s47, s47, 7
    s_mul_i32 s59, s47, 176128
    s_add_u32 s47, s46, 2
    s_and_b32 s47, s47, 7
    s_mul_i32 s60, s47, 176128
    s_add_u32 s47, s46, 3
    s_and_b32 s47, s47, 7
    s_mul_i32 s61, s47, 176128
    s_add_u32 s47, s46, 4
    s_and_b32 s47, s47, 7
    s_mul_i32 s62, s47, 176128
    s_add_u32 s47, s46, 5
    s_and_b32 s47, s47, 7
    s_mul_i32 s63, s47, 176128
    s_add_u32 s47, s46, 6
    s_and_b32 s47, s47, 7
    s_mul_i32 s64, s47, 176128
    s_add_u32 s47, s46, 7
    s_and_b32 s47, s47, 7
    s_mul_i32 s65, s47, 176128
    v_subrev_u32 v48, 65536, v36
    v_subrev_u32 v49, 65536, v37
    v_subrev_u32 v50, 65536, v38
    v_subrev_u32 v51, 65536, v39
    v_mov_b32 v40, 0
    v_mov_b32 v41, 0
    v_mov_b32 v42, 0
    v_mov_b32 v43, 0
    s_lshl_b32 s47, s3, 10
    s_add_u32 s47, s47, 155904
    v_lshl_add_u32 v45, v1, 3, s47
    v_and_b32 v2, 1, v1
    v_lshlrev_b32 v2, 4, v2
    v_mov_b32 v3, 0x3f80
    v_lshlrev_b32 v2, v2, v3
    v_and_b32 v3, 2, v1
    v_cmp_eq_u32 vcc, 0, v3
    s_nop 1
    v_cndmask_b32 v84, 0, v2, vcc
    v_sub_u32 v85, v2, v84
    s_waitcnt vmcnt(4)
    s_add_u32 m0, s50, 8192
    s_nop 0
    buffer_load_dwordx4 v32, s[24:27], s56 offen offset:0 lds
    buffer_load_dwordx4 v33, s[24:27], s56 offen offset:1024 lds
    buffer_load_dwordx4 v34, s[24:27], s56 offen offset:2048 lds
    buffer_load_dwordx4 v35, s[24:27], s56 offen offset:3072 lds
    ds_read_b128 v[192:195], v36 offset:0
    ds_read_b128 v[196:199], v37 offset:0
    ds_read_b128 v[200:203], v38 offset:0
    ds_read_b128 v[204:207], v39 offset:0
    s_waitcnt lgkmcnt(0)
    s_waitcnt vmcnt(4)
    s_add_u32 m0, s50, 12288
    s_nop 0
    buffer_load_dwordx4 v32, s[24:27], s57 offen offset:0 lds
    buffer_load_dwordx4 v33, s[24:27], s57 offen offset:1024 lds
    buffer_load_dwordx4 v34, s[24:27], s57 offen offset:2048 lds
    buffer_load_dwordx4 v35, s[24:27], s57 offen offset:3072 lds
    ds_read_b128 v[208:211], v36 offset:4096
    ds_read_b128 v[212:215], v37 offset:4096
    ds_read_b128 v[216:219], v38 offset:4096
    ds_read_b128 v[220:223], v39 offset:4096
    v_dot2_f32_bf16 v40, v192, s49, v40
    v_dot2_f32_bf16 v41, v192, v192, v41
    v_dot2_f32_bf16 v42, v193, s49, v42
    v_dot2_f32_bf16 v43, v193, v193, v43
    v_dot2_f32_bf16 v40, v194, s49, v40
    v_dot2_f32_bf16 v41, v194, v194, v41
    v_dot2_f32_bf16 v42, v195, s49, v42
    v_dot2_f32_bf16 v43, v195, v195, v43
    v_dot2_f32_bf16 v40, v196, s49, v40
    v_dot2_f32_bf16 v41, v196, v196, v41
    v_dot2_f32_bf16 v42, v197, s49, v42
    v_dot2_f32_bf16 v43, v197, v197, v43
    v_dot2_f32_bf16 v40, v198, s49, v40
    v_dot2_f32_bf16 v41, v198, v198, v41
    v_dot2_f32_bf16 v42, v199, s49, v42
    v_dot2_f32_bf16 v43, v199, v199, v43
    v_dot2_f32_bf16 v40, v200, s49, v40
    v_dot2_f32_bf16 v41, v200, v200, v41
    v_dot2_f32_bf16 v42, v201, s49, v42
    v_dot2_f32_bf16 v43, v201, v201, v43
    v_dot2_f32_bf16 v40, v202, s49, v40
    v_dot2_f32_bf16 v41, v202, v202, v41
    v_dot2_f32_bf16 v42, v203, s49, v42
    v_dot2_f32_bf16 v43, v203, v203, v43
    v_dot2_f32_bf16 v40, v204, s49, v40
    v_dot2_f32_bf16 v41, v204, v204, v41
    v_dot2_f32_bf16 v42, v205, s49, v42
    v_dot2_f32_bf16 v43, v205, v205, v43
    v_dot2_f32_bf16 v40, v206, s49, v40
    v_dot2_f32_bf16 v41, v206, v206, v41
    v_dot2_f32_bf16 v42, v207, s49, v42
    v_dot2_f32_bf16 v43, v207, v207, v43
    s_waitcnt lgkmcnt(0)
    s_waitcnt vmcnt(4)
    ds_read_b128 v[224:227], v36 offset:8192
    ds_read_b128 v[228:231], v37 offset:8192
    ds_read_b128 v[232:235], v38 offset:8192
    ds_read_b128 v[236:239], v39 offset:8192
    v_dot2_f32_bf16 v40, v208, s49, v40
    v_dot2_f32_bf16 v41, v208, v208, v41
    v_dot2_f32_bf16 v42, v209, s49, v42
    v_dot2_f32_bf16 v43, v209, v209, v43
    v_dot2_f32_bf16 v40, v210, s49, v40
    v_dot2_f32_bf16 v41, v210, v210, v41
    v_dot2_f32_bf16 v42, v211, s49, v42
    v_dot2_f32_bf16 v43, v211, v211, v43
    v_dot2_f32_bf16 v40, v212, s49, v40
    v_dot2_f32_bf16 v41, v212, v212, v41
    v_dot2_f32_bf16 v42, v213, s49, v42
    v_dot2_f32_bf16 v43, v213, v213, v43
    v_dot2_f32_bf16 v40, v214, s49, v40
    v_dot2_f32_bf16 v41, v214, v214, v41
    v_dot2_f32_bf16 v42, v215, s49, v42
    v_dot2_f32_bf16 v43, v215, v215, v43
    v_dot2_f32_bf16 v40, v216, s49, v40
    v_dot2_f32_bf16 v41, v216, v216, v41
    v_dot2_f32_bf16 v42, v217, s49, v42
    v_dot2_f32_bf16 v43, v217, v217, v43
    v_dot2_f32_bf16 v40, v218, s49, v40
    v_dot2_f32_bf16 v41, v218, v218, v41
    v_dot2_f32_bf16 v42, v219, s49, v42
    v_dot2_f32_bf16 v43, v219, v219, v43
    v_dot2_f32_bf16 v40, v220, s49, v40
    v_dot2_f32_bf16 v41, v220, v220, v41
    v_dot2_f32_bf16 v42, v221, s49, v42
    v_dot2_f32_bf16 v43, v221, v221, v43
    v_dot2_f32_bf16 v40, v222, s49, v40
    v_dot2_f32_bf16 v41, v222, v222, v41
    v_dot2_f32_bf16 v42, v223, s49, v42
    v_dot2_f32_bf16 v43, v223, v223, v43
    s_waitcnt lgkmcnt(0)
    s_waitcnt vmcnt(0)
    ds_read_b128 v[240:243], v36 offset:12288
    ds_read_b128 v[244:247], v37 offset:12288
    ds_read_b128 v[248:251], v38 offset:12288
    ds_read_b128 v[252:255], v39 offset:12288
    v_dot2_f32_bf16 v40, v224, s49, v40
    v_dot2_f32_bf16 v41, v224, v224, v41
    v_dot2_f32_bf16 v42, v225, s49, v42
    v_dot2_f32_bf16 v43, v225, v225, v43
    v_dot2_f32_bf16 v40, v226, s49, v40
    v_dot2_f32_bf16 v41, v226, v226, v41
    v_dot2_f32_bf16 v42, v227, s49, v42
    v_dot2_f32_bf16 v43, v227, v227, v43
    v_dot2_f32_bf16 v40, v228, s49, v40
    v_dot2_f32_bf16 v41, v228, v228, v41
    v_dot2_f32_bf16 v42, v229, s49, v42
    v_dot2_f32_bf16 v43, v229, v229, v43
    v_dot2_f32_bf16 v40, v230, s49, v40
    v_dot2_f32_bf16 v41, v230, v230, v41
    v_dot2_f32_bf16 v42, v231, s49, v42
    v_dot2_f32_bf16 v43, v231, v231, v43
    v_dot2_f32_bf16 v40, v232, s49, v40
    v_dot2_f32_bf16 v41, v232, v232, v41
    v_dot2_f32_bf16 v42, v233, s49, v42
    v_dot2_f32_bf16 v43, v233, v233, v43
    v_dot2_f32_bf16 v40, v234, s49, v40
    v_dot2_f32_bf16 v41, v234, v234, v41
    v_dot2_f32_bf16 v42, v235, s49, v42
    v_dot2_f32_bf16 v43, v235, v235, v43
    v_dot2_f32_bf16 v40, v236, s49, v40
    v_dot2_f32_bf16 v41, v236, v236, v41
    v_dot2_f32_bf16 v42, v237, s49, v42
    v_dot2_f32_bf16 v43, v237, v237, v43
    v_dot2_f32_bf16 v40, v238, s49, v40
    v_dot2_f32_bf16 v41, v238, v238, v41
    v_dot2_f32_bf16 v42, v239, s49, v42
    v_dot2_f32_bf16 v43, v239, v239, v43
    s_waitcnt lgkmcnt(0)
    v_dot2_f32_bf16 v40, v240, s49, v40
    v_dot2_f32_bf16 v41, v240, v240, v41
    v_dot2_f32_bf16 v42, v241, s49, v42
    v_dot2_f32_bf16 v43, v241, v241, v43
    v_dot2_f32_bf16 v40, v242, s49, v40
    v_dot2_f32_bf16 v41, v242, v242, v41
    v_dot2_f32_bf16 v42, v243, s49, v42
    v_dot2_f32_bf16 v43, v243, v243, v43
    v_dot2_f32_bf16 v40, v244, s49, v40
    v_dot2_f32_bf16 v41, v244, v244, v41
    v_dot2_f32_bf16 v42, v245, s49, v42
    v_dot2_f32_bf16 v43, v245, v245, v43
    v_dot2_f32_bf16 v40, v246, s49, v40
    v_dot2_f32_bf16 v41, v246, v246, v41
    v_dot2_f32_bf16 v42, v247, s49, v42
    v_dot2_f32_bf16 v43, v247, v247, v43
    v_dot2_f32_bf16 v40, v248, s49, v40
    v_dot2_f32_bf16 v41, v248, v248, v41
    v_dot2_f32_bf16 v42, v249, s49, v42
    v_dot2_f32_bf16 v43, v249, v249, v43
    v_dot2_f32_bf16 v40, v250, s49, v40
    v_dot2_f32_bf16 v41, v250, v250, v41
    v_dot2_f32_bf16 v42, v251, s49, v42
    v_dot2_f32_bf16 v43, v251, v251, v43
    v_dot2_f32_bf16 v40, v252, s49, v40
    v_dot2_f32_bf16 v41, v252, v252, v41
    v_dot2_f32_bf16 v42, v253, s49, v42
    v_dot2_f32_bf16 v43, v253, v253, v43
    v_dot2_f32_bf16 v40, v254, s49, v40
    v_dot2_f32_bf16 v41, v254, v254, v41
    v_dot2_f32_bf16 v42, v255, s49, v42
    v_dot2_f32_bf16 v43, v255, v255, v43
    s_nop 1
    v_add_f32 v40, v40, v42
    v_add_f32 v41, v41, v43
    ds_write_b64 v45, v[40:41] offset:512
    s_waitcnt lgkmcnt(0)
    s_barrier
    ds_read_b64 v[42:43], v45 offset:0
    ds_read_b128 v[128:131], v48 offset:0
    ds_read_b128 v[132:135], v49 offset:0
    ds_read_b128 v[136:139], v50 offset:0
    ds_read_b128 v[140:143], v51 offset:0
    ds_read_b128 v[144:147], v48 offset:4096
    ds_read_b128 v[148:151], v49 offset:4096
    ds_read_b128 v[152:155], v50 offset:4096
    ds_read_b128 v[156:159], v51 offset:4096
    ds_read_b128 v[160:163], v48 offset:8192
    ds_read_b128 v[164:167], v49 offset:8192
    ds_read_b128 v[168:171], v50 offset:8192
    ds_read_b128 v[172:175], v51 offset:8192
    s_waitcnt lgkmcnt(12)
    v_add_f32 v40, v40, v42
    v_add_f32 v42, v41, v43
    v_mov_b32 v41, v40
    v_mov_b32 v43, v42
    s_nop 0
    v_permlane32_swap_b32 v40, v41
    v_permlane32_swap_b32 v42, v43
    v_add_f32 v40, v40, v41
    v_add_f32 v42, v42, v43
    v_mul_f32 v80, 0xbb000000, v40
    v_mul_f32 v81, 0xbb000000, v40
    v_mul_f32 v82, 0xbb000000, v40
    v_mul_f32 v83, 0xbb000000, v40
    ds_read_b128 v[176:179], v48 offset:12288
    ds_read_b128 v[180:183], v49 offset:12288
    ds_read_b128 v[184:187], v50 offset:12288
    ds_read_b128 v[188:191], v51 offset:12288
    v_mfma_f32_4x4x4_16b_bf16 v[64:67], v[84:85], v[192:193], v[80:83]
    v_mfma_f32_4x4x4_16b_bf16 v[68:71], v[84:85], v[194:195], v[80:83]
    s_waitcnt lgkmcnt(0)
    s_barrier
    v_mfma_f32_4x4x4_16b_bf16 v[72:75], v[84:85], v[196:197], v[80:83]
    v_mfma_f32_4x4x4_16b_bf16 v[76:79], v[84:85], v[198:199], v[80:83]
    v_cvt_pk_bf16_f32 v192, v64, v65
    v_cvt_pk_bf16_f32 v193, v66, v67
    v_cvt_pk_bf16_f32 v194, v68, v69
    v_cvt_pk_bf16_f32 v195, v70, v71
    ds_write_b128 v46, v[192:195] offset:0
    v_mfma_f32_4x4x4_16b_bf16 v[64:67], v[84:85], v[200:201], v[80:83]
    v_mfma_f32_4x4x4_16b_bf16 v[68:71], v[84:85], v[202:203], v[80:83]
    v_cvt_pk_bf16_f32 v196, v72, v73
    v_cvt_pk_bf16_f32 v197, v74, v75
    v_cvt_pk_bf16_f32 v198, v76, v77
    v_cvt_pk_bf16_f32 v199, v78, v79
    ds_write_b128 v46, v[196:199] offset:1024
    v_mfma_f32_4x4x4_16b_bf16 v[72:75], v[84:85], v[204:205], v[80:83]
    v_mfma_f32_4x4x4_16b_bf16 v[76:79], v[84:85], v[206:207], v[80:83]
    v_cvt_pk_bf16_f32 v200, v64, v65
    v_cvt_pk_bf16_f32 v201, v66, v67
    v_cvt_pk_bf16_f32 v202, v68, v69
    v_cvt_pk_bf16_f32 v203, v70, v71
    ds_write_b128 v46, v[200:203] offset:2048
    v_mfma_f32_4x4x4_16b_bf16 v[64:67], v[84:85], v[208:209], v[80:83]
    v_mfma_f32_4x4x4_16b_bf16 v[68:71], v[84:85], v[210:211], v[80:83]
    v_cvt_pk_bf16_f32 v204, v72, v73
    v_cvt_pk_bf16_f32 v205, v74, v75
    v_cvt_pk_bf16_f32 v206, v76, v77
    v_cvt_pk_bf16_f32 v207, v78, v79
    ds_write_b128 v46, v[204:207] offset:3072
    v_mfma_f32_4x4x4_16b_bf16 v[72:75], v[84:85], v[212:213], v[80:83]
    v_mfma_f32_4x4x4_16b_bf16 v[76:79], v[84:85], v[214:215], v[80:83]
    v_cvt_pk_bf16_f32 v208, v64, v65
    v_cvt_pk_bf16_f32 v209, v66, v67
    v_cvt_pk_bf16_f32 v210, v68, v69
    v_cvt_pk_bf16_f32 v211, v70, v71
    ds_write_b128 v46, v[208:211] offset:4096
    v_mfma_f32_4x4x4_16b_bf16 v[64:67], v[84:85], v[216:217], v[80:83]
    v_mfma_f32_4x4x4_16b_bf16 v[68:71], v[84:85], v[218:219], v[80:83]
    v_cvt_pk_bf16_f32 v212, v72, v73
    v_cvt_pk_bf16_f32 v213, v74, v75
    v_cvt_pk_bf16_f32 v214, v76, v77
    v_cvt_pk_bf16_f32 v215, v78, v79
    ds_write_b128 v46, v[212:215] offset:5120
    v_mfma_f32_4x4x4_16b_bf16 v[72:75], v[84:85], v[220:221], v[80:83]
    v_mfma_f32_4x4x4_16b_bf16 v[76:79], v[84:85], v[222:223], v[80:83]
    v_cvt_pk_bf16_f32 v216, v64, v65
    v_cvt_pk_bf16_f32 v217, v66, v67
    v_cvt_pk_bf16_f32 v218, v68, v69
    v_cvt_pk_bf16_f32 v219, v70, v71
    ds_write_b128 v46, v[216:219] offset:6144
    v_mfma_f32_4x4x4_16b_bf16 v[64:67], v[84:85], v[224:225], v[80:83]
    v_mfma_f32_4x4x4_16b_bf16 v[68:71], v[84:85], v[226:227], v[80:83]
    v_cvt_pk_bf16_f32 v220, v72, v73
    v_cvt_pk_bf16_f32 v221, v74, v75
    v_cvt_pk_bf16_f32 v222, v76, v77
    v_cvt_pk_bf16_f32 v223, v78, v79
    ds_write_b128 v46, v[220:223] offset:7168
    s_barrier
    v_mfma_f32_4x4x4_16b_bf16 v[72:75], v[84:85], v[228:229], v[80:83]
    v_mfma_f32_4x4x4_16b_bf16 v[76:79], v[84:85], v[230:231], v[80:83]
    v_cvt_pk_bf16_f32 v224, v64, v65
    v_cvt_pk_bf16_f32 v225, v66, v67
    v_cvt_pk_bf16_f32 v226, v68, v69
    v_cvt_pk_bf16_f32 v227, v70, v71
    ds_write_b128 v46, v[224:227] offset:8192
    v_mfma_f32_4x4x4_16b_bf16 v[64:67], v[84:85], v[232:233], v[80:83]
    v_mfma_f32_4x4x4_16b_bf16 v[68:71], v[84:85], v[234:235], v[80:83]
    v_cvt_pk_bf16_f32 v228, v72, v73
    v_cvt_pk_bf16_f32 v229, v74, v75
    v_cvt_pk_bf16_f32 v230, v76, v77
    v_cvt_pk_bf16_f32 v231, v78, v79
    ds_write_b128 v46, v[228:231] offset:9216
    v_mfma_f32_4x4x4_16b_bf16 v[72:75], v[84:85], v[236:237], v[80:83]
    v_mfma_f32_4x4x4_16b_bf16 v[76:79], v[84:85], v[238:239], v[80:83]
    v_cvt_pk_bf16_f32 v232, v64, v65
    v_cvt_pk_bf16_f32 v233, v66, v67
    v_cvt_pk_bf16_f32 v234, v68, v69
    v_cvt_pk_bf16_f32 v235, v70, v71
    ds_write_b128 v46, v[232:235] offset:10240
    v_mfma_f32_4x4x4_16b_bf16 v[64:67], v[84:85], v[240:241], v[80:83]
    v_mfma_f32_4x4x4_16b_bf16 v[68:71], v[84:85], v[242:243], v[80:83]
    v_cvt_pk_bf16_f32 v236, v72, v73
    v_cvt_pk_bf16_f32 v237, v74, v75
    v_cvt_pk_bf16_f32 v238, v76, v77
    v_cvt_pk_bf16_f32 v239, v78, v79
    ds_write_b128 v46, v[236:239] offset:11264
    v_mfma_f32_4x4x4_16b_bf16 v[72:75], v[84:85], v[244:245], v[80:83]
    v_mfma_f32_4x4x4_16b_bf16 v[76:79], v[84:85], v[246:247], v[80:83]
    v_cvt_pk_bf16_f32 v240, v64, v65
    v_cvt_pk_bf16_f32 v241, v66, v67
    v_cvt_pk_bf16_f32 v242, v68, v69
    v_cvt_pk_bf16_f32 v243, v70, v71
    ds_write_b128 v46, v[240:243] offset:12288
    v_mfma_f32_4x4x4_16b_bf16 v[64:67], v[84:85], v[248:249], v[80:83]
    v_mfma_f32_4x4x4_16b_bf16 v[68:71], v[84:85], v[250:251], v[80:83]
    v_cvt_pk_bf16_f32 v244, v72, v73
    v_cvt_pk_bf16_f32 v245, v74, v75
    v_cvt_pk_bf16_f32 v246, v76, v77
    v_cvt_pk_bf16_f32 v247, v78, v79
    ds_write_b128 v46, v[244:247] offset:13312
    s_barrier
    v_mfma_f32_4x4x4_16b_bf16 v[72:75], v[84:85], v[252:253], v[80:83]
    v_mfma_f32_4x4x4_16b_bf16 v[76:79], v[84:85], v[254:255], v[80:83]
    v_cvt_pk_bf16_f32 v248, v64, v65
    v_cvt_pk_bf16_f32 v249, v66, v67
    v_cvt_pk_bf16_f32 v250, v68, v69
    v_cvt_pk_bf16_f32 v251, v70, v71
    ds_write_b128 v46, v[248:251] offset:14336
    v_mfma_f32_4x4x4_16b_bf16 v[64:67], v[84:85], v[128:129], v[80:83]
    v_mfma_f32_4x4x4_16b_bf16 v[68:71], v[84:85], v[130:131], v[80:83]
    v_cvt_pk_bf16_f32 v252, v72, v73
    v_cvt_pk_bf16_f32 v253, v74, v75
    v_cvt_pk_bf16_f32 v254, v76, v77
    v_cvt_pk_bf16_f32 v255, v78, v79
    ds_write_b128 v46, v[252:255] offset:15360
    s_waitcnt lgkmcnt(0)
    s_barrier
    s_add_u32 m0, s66, 131072
    s_nop 0
    buffer_load_dwordx4 v5, s[32:35], s58 offen offset:0 lds
    buffer_load_dwordx4 v6, s[32:35], s58 offen offset:1024 lds
    buffer_load_dwordx4 v7, s[32:35], s58 offen offset:2048 lds
    s_add_u32 m0, s66, 143392
    s_nop 0
    buffer_load_dwordx4 v5, s[36:39], s58 offen offset:0 lds
    buffer_load_dwordx4 v6, s[36:39], s58 offen offset:1024 lds
    buffer_load_dwordx4 v7, s[36:39], s58 offen offset:2048 lds
    v_mfma_f32_4x4x4_16b_bf16 v[72:75], v[84:85], v[132:133], v[80:83]
    v_mfma_f32_4x4x4_16b_bf16 v[76:79], v[84:85], v[134:135], v[80:83]
    v_cvt_pk_bf16_f32 v128, v64, v65
    v_cvt_pk_bf16_f32 v129, v66, v67
    v_cvt_pk_bf16_f32 v130, v68, v69
    v_cvt_pk_bf16_f32 v131, v70, v71
    v_mfma_f32_4x4x4_16b_bf16 v[64:67], v[84:85], v[136:137], v[80:83]
    v_mfma_f32_4x4x4_16b_bf16 v[68:71], v[84:85], v[138:139], v[80:83]
    v_cvt_pk_bf16_f32 v132, v72, v73
    v_cvt_pk_bf16_f32 v133, v74, v75
    v_cvt_pk_bf16_f32 v134, v76, v77
    v_cvt_pk_bf16_f32 v135, v78, v79
    v_mfma_f32_4x4x4_16b_bf16 v[72:75], v[84:85], v[140:141], v[80:83]
    v_mfma_f32_4x4x4_16b_bf16 v[76:79], v[84:85], v[142:143], v[80:83]
    v_cvt_pk_bf16_f32 v136, v64, v65
    v_cvt_pk_bf16_f32 v137, v66, v67
    v_cvt_pk_bf16_f32 v138, v68, v69
    v_cvt_pk_bf16_f32 v139, v70, v71
    v_mfma_f32_4x4x4_16b_bf16 v[64:67], v[84:85], v[144:145], v[80:83]
    v_mfma_f32_4x4x4_16b_bf16 v[68:71], v[84:85], v[146:147], v[80:83]
    v_cvt_pk_bf16_f32 v140, v72, v73
    v_cvt_pk_bf16_f32 v141, v74, v75
    v_cvt_pk_bf16_f32 v142, v76, v77
    v_cvt_pk_bf16_f32 v143, v78, v79
    v_mfma_f32_4x4x4_16b_bf16 v[72:75], v[84:85], v[148:149], v[80:83]
    v_mfma_f32_4x4x4_16b_bf16 v[76:79], v[84:85], v[150:151], v[80:83]
    v_cvt_pk_bf16_f32 v144, v64, v65
    v_cvt_pk_bf16_f32 v145, v66, v67
    v_cvt_pk_bf16_f32 v146, v68, v69
    v_cvt_pk_bf16_f32 v147, v70, v71
    v_mfma_f32_4x4x4_16b_bf16 v[64:67], v[84:85], v[152:153], v[80:83]
    v_mfma_f32_4x4x4_16b_bf16 v[68:71], v[84:85], v[154:155], v[80:83]
    v_cvt_pk_bf16_f32 v148, v72, v73
    v_cvt_pk_bf16_f32 v149, v74, v75
    v_cvt_pk_bf16_f32 v150, v76, v77
    v_cvt_pk_bf16_f32 v151, v78, v79
    v_mfma_f32_4x4x4_16b_bf16 v[72:75], v[84:85], v[156:157], v[80:83]
    v_mfma_f32_4x4x4_16b_bf16 v[76:79], v[84:85], v[158:159], v[80:83]
    v_cvt_pk_bf16_f32 v152, v64, v65
    v_cvt_pk_bf16_f32 v153, v66, v67
    v_cvt_pk_bf16_f32 v154, v68, v69
    v_cvt_pk_bf16_f32 v155, v70, v71
    v_mfma_f32_4x4x4_16b_bf16 v[64:67], v[84:85], v[160:161], v[80:83]
    v_mfma_f32_4x4x4_16b_bf16 v[68:71], v[84:85], v[162:163], v[80:83]
    v_cvt_pk_bf16_f32 v156, v72, v73
    v_cvt_pk_bf16_f32 v157, v74, v75
    v_cvt_pk_bf16_f32 v158, v76, v77
    v_cvt_pk_bf16_f32 v159, v78, v79
    s_barrier
    v_mfma_f32_4x4x4_16b_bf16 v[72:75], v[84:85], v[164:165], v[80:83]
    v_mfma_f32_4x4x4_16b_bf16 v[76:79], v[84:85], v[166:167], v[80:83]
    v_cvt_pk_bf16_f32 v160, v64, v65
    v_cvt_pk_bf16_f32 v161, v66, v67
    v_cvt_pk_bf16_f32 v162, v68, v69
    v_cvt_pk_bf16_f32 v163, v70, v71
    v_mfma_f32_4x4x4_16b_bf16 v[64:67], v[84:85], v[168:169], v[80:83]
    v_mfma_f32_4x4x4_16b_bf16 v[68:71], v[84:85], v[170:171], v[80:83]
    v_cvt_pk_bf16_f32 v164, v72, v73
    v_cvt_pk_bf16_f32 v165, v74, v75
    v_cvt_pk_bf16_f32 v166, v76, v77
    v_cvt_pk_bf16_f32 v167, v78, v79
    v_mfma_f32_4x4x4_16b_bf16 v[72:75], v[84:85], v[172:173], v[80:83]
    v_mfma_f32_4x4x4_16b_bf16 v[76:79], v[84:85], v[174:175], v[80:83]
    v_cvt_pk_bf16_f32 v168, v64, v65
    v_cvt_pk_bf16_f32 v169, v66, v67
    v_cvt_pk_bf16_f32 v170, v68, v69
    v_cvt_pk_bf16_f32 v171, v70, v71
    v_mfma_f32_4x4x4_16b_bf16 v[64:67], v[84:85], v[176:177], v[80:83]
    v_mfma_f32_4x4x4_16b_bf16 v[68:71], v[84:85], v[178:179], v[80:83]
    v_cvt_pk_bf16_f32 v172, v72, v73
    v_cvt_pk_bf16_f32 v173, v74, v75
    v_cvt_pk_bf16_f32 v174, v76, v77
    v_cvt_pk_bf16_f32 v175, v78, v79
    v_mfma_f32_4x4x4_16b_bf16 v[72:75], v[84:85], v[180:181], v[80:83]
    v_mfma_f32_4x4x4_16b_bf16 v[76:79], v[84:85], v[182:183], v[80:83]
    v_cvt_pk_bf16_f32 v176, v64, v65
    v_cvt_pk_bf16_f32 v177, v66, v67
    v_cvt_pk_bf16_f32 v178, v68, v69
    v_cvt_pk_bf16_f32 v179, v70, v71
    v_mfma_f32_4x4x4_16b_bf16 v[64:67], v[84:85], v[184:185], v[80:83]
    v_mfma_f32_4x4x4_16b_bf16 v[68:71], v[84:85], v[186:187], v[80:83]
    v_cvt_pk_bf16_f32 v180, v72, v73
    v_cvt_pk_bf16_f32 v181, v74, v75
    v_cvt_pk_bf16_f32 v182, v76, v77
    v_cvt_pk_bf16_f32 v183, v78, v79
    v_mfma_f32_4x4x4_16b_bf16 v[72:75], v[84:85], v[188:189], v[80:83]
    v_mfma_f32_4x4x4_16b_bf16 v[76:79], v[84:85], v[190:191], v[80:83]
    v_cvt_pk_bf16_f32 v184, v64, v65
    v_cvt_pk_bf16_f32 v185, v66, v67
    v_cvt_pk_bf16_f32 v186, v68, v69
    v_cvt_pk_bf16_f32 v187, v70, v71
    v_cvt_pk_bf16_f32 v188, v72, v73
    v_cvt_pk_bf16_f32 v189, v74, v75
    v_cvt_pk_bf16_f32 v190, v76, v77
    v_cvt_pk_bf16_f32 v191, v78, v79
    s_barrier
    s_add_u32 m0, s66, 84224
    s_nop 0
    buffer_load_dwordx4 v5, s[32:35], s59 offen offset:0 lds
    buffer_load_dwordx4 v6, s[32:35], s59 offen offset:1024 lds
    buffer_load_dwordx4 v7, s[32:35], s59 offen offset:2048 lds
    s_add_u32 m0, s66, 96544
    s_nop 0
    buffer_load_dwordx4 v5, s[36:39], s59 offen offset:0 lds
    buffer_load_dwordx4 v6, s[36:39], s59 offen offset:1024 lds
    buffer_load_dwordx4 v7, s[36:39], s59 offen offset:2048 lds
    s_barrier
    s_waitcnt vmcnt(6)
    s_lshl_b32 s47, s3, 2
    s_add_u32 s47, s47, 160272
    v_mov_b32 v4, s47
    v_mov_b32 v3, 1
    s_barrier
    s_setprio 0
    s_cmp_eq_u32 s45, 15
    s_cbranch_scc1 fb_gu_skip
    s_mov_b64 exec, 1
    ds_add_u32 v4, v3
    s_mov_b64 exec, -1
    ds_read_b64_tr_b16 v[12:13], v8 offset:0
    ds_read_b64_tr_b16 v[14:15], v8 offset:768
    ds_read_b64_tr_b16 v[16:17], v8 offset:32
    ds_read_b64_tr_b16 v[18:19], v8 offset:800
    ds_read_b64_tr_b16 v[20:21], v8 offset:64
    ds_read_b64_tr_b16 v[22:23], v8 offset:832
    ds_read_b64_tr_b16 v[24:25], v8 offset:96
    ds_read_b64_tr_b16 v[26:27], v8 offset:864
    s_waitcnt lgkmcnt(6)
    v_mfma_f32_32x32x16_bf16 v[32:47], v[12:15], v[128:131], 0
    ds_read_b64_tr_b16 v[28:29], v8 offset:128
    ds_read_b64_tr_b16 v[30:31], v8 offset:896
    s_waitcnt lgkmcnt(6)
    v_mfma_f32_32x32x16_bf16 v[48:63], v[16:19], v[128:131], 0
    ds_read_b64_tr_b16 v[12:13], v8 offset:160
    ds_read_b64_tr_b16 v[14:15], v8 offset:928
    s_waitcnt lgkmcnt(6)
    v_mfma_f32_32x32x16_bf16 v[64:79], v[20:23], v[128:131], 0
    ds_read_b64_tr_b16 v[16:17], v8 offset:3072
    ds_read_b64_tr_b16 v[18:19], v8 offset:3840
    s_waitcnt lgkmcnt(6)
    v_mfma_f32_32x32x16_bf16 v[80:95], v[24:27], v[128:131], 0
    ds_read_b64_tr_b16 v[20:21], v8 offset:3104
    ds_read_b64_tr_b16 v[22:23], v8 offset:3872
    s_waitcnt lgkmcnt(6)
    v_mfma_f32_32x32x16_bf16 v[96:111], v[28:31], v[128:131], 0
    ds_read_b64_tr_b16 v[24:25], v8 offset:3136
    ds_read_b64_tr_b16 v[26:27], v8 offset:3904
    s_waitcnt lgkmcnt(6)
    v_mfma_f32_32x32x16_bf16 v[112:127], v[12:15], v[128:131], 0
    ds_read_b64_tr_b16 v[28:29], v8 offset:3168
    ds_read_b64_tr_b16 v[30:31], v8 offset:3936
    s_waitcnt lgkmcnt(6)
    v_mfma_f32_32x32x16_bf16 v[32:47], v[16:19], v[132:135], v[32:47]
    ds_read_b64_tr_b16 v[12:13], v8 offset:3200
    ds_read_b64_tr_b16 v[14:15], v8 offset:3968
    s_waitcnt lgkmcnt(6)
    v_mfma_f32_32x32x16_bf16 v[48:63], v[20:23], v[132:135], v[48:63]
    ds_read_b64_tr_b16 v[16:17], v8 offset:3232
    ds_read_b64_tr_b16 v[18:19], v8 offset:4000
    s_add_u32 m0, s66, 59392
    s_nop 0
    buffer_load_dwordx4 v5, s[32:35], s60 offen offset:0 lds
    s_waitcnt lgkmcnt(6)
    v_mfma_f32_32x32x16_bf16 v[64:79], v[24:27], v[132:135], v[64:79]
    ds_read_b64_tr_b16 v[20:21], v8 offset:6144
    ds_read_b64_tr_b16 v[22:23], v8 offset:6912
    s_waitcnt lgkmcnt(6)
    v_mfma_f32_32x32x16_bf16 v[80:95], v[28:31], v[132:135], v[80:95]
    ds_read_b64_tr_b16 v[24:25], v8 offset:6176
    ds_read_b64_tr_b16 v[26:27], v8 offset:6944
    buffer_load_dwordx4 v6, s[32:35], s60 offen offset:1024 lds
    s_waitcnt lgkmcnt(6)
    v_mfma_f32_32x32x16_bf16 v[96:111], v[12:15], v[132:135], v[96:111]
    ds_read_b64_tr_b16 v[28:29], v8 offset:6208
    ds_read_b64_tr_b16 v[30:31], v8 offset:6976
    s_waitcnt lgkmcnt(6)
    v_mfma_f32_32x32x16_bf16 v[112:127], v[16:19], v[132:135], v[112:127]
    ds_read_b64_tr_b16 v[12:13], v8 offset:6240
    ds_read_b64_tr_b16 v[14:15], v8 offset:7008
    buffer_load_dwordx4 v7, s[32:35], s60 offen offset:2048 lds
    s_waitcnt lgkmcnt(6)
    v_mfma_f32_32x32x16_bf16 v[32:47], v[20:23], v[136:139], v[32:47]
    ds_read_b64_tr_b16 v[16:17], v8 offset:6272
    ds_read_b64_tr_b16 v[18:19], v8 offset:7040
    s_waitcnt lgkmcnt(6)
    v_mfma_f32_32x32x16_bf16 v[48:63], v[24:27], v[136:139], v[48:63]
    ds_read_b64_tr_b16 v[20:21], v8 offset:6304
    ds_read_b64_tr_b16 v[22:23], v8 offset:7072
    s_add_u32 m0, s66, 71712
    s_nop 0
    buffer_load_dwordx4 v5, s[36:39], s60 offen offset:0 lds
    s_waitcnt lgkmcnt(6)
    v_mfma_f32_32x32x16_bf16 v[64:79], v[28:31], v[136:139], v[64:79]
    ds_read_b64_tr_b16 v[24:25], v8 offset:9216
    ds_read_b64_tr_b16 v[26:27], v8 offset:9984
    s_waitcnt lgkmcnt(6)
    v_mfma_f32_32x32x16_bf16 v[80:95], v[12:15], v[136:139], v[80:95]
    ds_read_b64_tr_b16 v[28:29], v8 offset:9248
    ds_read_b64_tr_b16 v[30:31], v8 offset:10016
    s_waitcnt vmcnt(4)
    s_mov_b64 exec, 1
    ds_add_u32 v4, v3
    s_mov_b64 exec, -1
    buffer_load_dwordx4 v6, s[36:39], s60 offen offset:1024 lds
    s_waitcnt lgkmcnt(7)
    v_mfma_f32_32x32x16_bf16 v[96:111], v[16:19], v[136:139], v[96:111]
    ds_read_b64_tr_b16 v[12:13], v8 offset:9280
    ds_read_b64_tr_b16 v[14:15], v8 offset:10048
    s_waitcnt lgkmcnt(7)
    v_mfma_f32_32x32x16_bf16 v[112:127], v[20:23], v[136:139], v[112:127]
    ds_read_b64_tr_b16 v[16:17], v8 offset:9312
    ds_read_b64_tr_b16 v[18:19], v8 offset:10080
    buffer_load_dwordx4 v7, s[36:39], s60 offen offset:2048 lds
    s_waitcnt lgkmcnt(7)
    v_mfma_f32_32x32x16_bf16 v[32:47], v[24:27], v[140:143], v[32:47]
    ds_read_b64_tr_b16 v[20:21], v8 offset:9344
    ds_read_b64_tr_b16 v[22:23], v8 offset:10112
    s_waitcnt lgkmcnt(7)
    v_mfma_f32_32x32x16_bf16 v[48:63], v[28:31], v[140:143], v[48:63]
    ds_read_b64_tr_b16 v[24:25], v8 offset:9376
    ds_read_b64_tr_b16 v[26:27], v8 offset:10144
    s_mov_b32 s51, 262144
    s_setprio 3
fb_sw1:
    ds_read_b32 v2, v10
    s_waitcnt lgkmcnt(0)
    v_cmp_gt_u32 vcc, 2, v2
    s_cbranch_vccz fb_sw1_ok
    s_sub_u32 s51, s51, 1
    s_cmp_lg_u32 s51, 0
    s_cbranch_scc1 fb_sw1
fb_sw1_ok:
    s_setprio 0
    s_add_u32 m0, s66, 0
    s_nop 0
    buffer_load_dwordx4 v5, s[32:35], s61 offen offset:0 lds
    v_mfma_f32_32x32x16_bf16 v[64:79], v[12:15], v[140:143], v[64:79]
    ds_read_b64_tr_b16 v[28:29], v9 offset:24832
    ds_read_b64_tr_b16 v[30:31], v9 offset:25600
    v_mfma_f32_32x32x16_bf16 v[80:95], v[16:19], v[140:143], v[80:95]
    ds_read_b64_tr_b16 v[12:13], v9 offset:24864
    ds_read_b64_tr_b16 v[14:15], v9 offset:25632
    v_mfma_f32_32x32x16_bf16 v[96:111], v[20:23], v[140:143], v[96:111]
    ds_read_b64_tr_b16 v[16:17], v9 offset:24896
    ds_read_b64_tr_b16 v[18:19], v9 offset:25664
    buffer_load_dwordx4 v6, s[32:35], s61 offen offset:1024 lds
    v_mfma_f32_32x32x16_bf16 v[112:127], v[24:27], v[140:143], v[112:127]
    ds_read_b64_tr_b16 v[20:21], v9 offset:24928
    ds_read_b64_tr_b16 v[22:23], v9 offset:25696
    s_waitcnt lgkmcnt(6)
    v_mfma_f32_32x32x16_bf16 v[32:47], v[28:31], v[144:147], v[32:47]
    ds_read_b64_tr_b16 v[24:25], v9 offset:24960
    ds_read_b64_tr_b16 v[26:27], v9 offset:25728
    s_waitcnt lgkmcnt(6)
    v_mfma_f32_32x32x16_bf16 v[48:63], v[12:15], v[144:147], v[48:63]
    ds_read_b64_tr_b16 v[28:29], v9 offset:24992
    ds_read_b64_tr_b16 v[30:31], v9 offset:25760
    buffer_load_dwordx4 v7, s[32:35], s61 offen offset:2048 lds
    s_waitcnt lgkmcnt(6)
    v_mfma_f32_32x32x16_bf16 v[64:79], v[16:19], v[144:147], v[64:79]
    ds_read_b64_tr_b16 v[12:13], v9 offset:27904
    ds_read_b64_tr_b16 v[14:15], v9 offset:28672
    s_waitcnt lgkmcnt(6)
    v_mfma_f32_32x32x16_bf16 v[80:95], v[20:23], v[144:147], v[80:95]
    ds_read_b64_tr_b16 v[16:17], v9 offset:27936
    ds_read_b64_tr_b16 v[18:19], v9 offset:28704
    s_waitcnt lgkmcnt(6)
    v_mfma_f32_32x32x16_bf16 v[96:111], v[24:27], v[144:147], v[96:111]
    ds_read_b64_tr_b16 v[20:21], v9 offset:27968
    ds_read_b64_tr_b16 v[22:23], v9 offset:28736
    s_add_u32 m0, s66, 12320
    s_nop 0
    buffer_load_dwordx4 v5, s[36:39], s61 offen offset:0 lds
    s_waitcnt lgkmcnt(6)
    v_mfma_f32_32x32x16_bf16 v[112:127], v[28:31], v[144:147], v[112:127]
    ds_read_b64_tr_b16 v[24:25], v9 offset:28000
    ds_read_b64_tr_b16 v[26:27], v9 offset:28768
    s_waitcnt lgkmcnt(6)
    v_mfma_f32_32x32x16_bf16 v[32:47], v[12:15], v[148:151], v[32:47]
    ds_read_b64_tr_b16 v[28:29], v9 offset:28032
    ds_read_b64_tr_b16 v[30:31], v9 offset:28800
    s_waitcnt lgkmcnt(6)
    v_mfma_f32_32x32x16_bf16 v[48:63], v[16:19], v[148:151], v[48:63]
    ds_read_b64_tr_b16 v[12:13], v9 offset:28064
    ds_read_b64_tr_b16 v[14:15], v9 offset:28832
    buffer_load_dwordx4 v6, s[36:39], s61 offen offset:1024 lds
    s_waitcnt lgkmcnt(6)
    v_mfma_f32_32x32x16_bf16 v[64:79], v[20:23], v[148:151], v[64:79]
    ds_read_b64_tr_b16 v[16:17], v9 offset:30976
    ds_read_b64_tr_b16 v[18:19], v9 offset:31744
    s_waitcnt lgkmcnt(6)
    v_mfma_f32_32x32x16_bf16 v[80:95], v[24:27], v[148:151], v[80:95]
    ds_read_b64_tr_b16 v[20:21], v9 offset:31008
    ds_read_b64_tr_b16 v[22:23], v9 offset:31776
    s_waitcnt lgkmcnt(6)
    v_mfma_f32_32x32x16_bf16 v[96:111], v[28:31], v[148:151], v[96:111]
    ds_read_b64_tr_b16 v[24:25], v9 offset:31040
    ds_read_b64_tr_b16 v[26:27], v9 offset:31808
    buffer_load_dwordx4 v7, s[36:39], s61 offen offset:2048 lds
    s_waitcnt lgkmcnt(6)
    v_mfma_f32_32x32x16_bf16 v[112:127], v[12:15], v[148:151], v[112:127]
    ds_read_b64_tr_b16 v[28:29], v9 offset:31072
    ds_read_b64_tr_b16 v[30:31], v9 offset:31840
    s_waitcnt lgkmcnt(6)
    v_mfma_f32_32x32x16_bf16 v[32:47], v[16:19], v[152:155], v[32:47]
    ds_read_b64_tr_b16 v[12:13], v9 offset:31104
    ds_read_b64_tr_b16 v[14:15], v9 offset:31872
    s_waitcnt lgkmcnt(6)
    v_mfma_f32_32x32x16_bf16 v[48:63], v[20:23], v[152:155], v[48:63]
    ds_read_b64_tr_b16 v[16:17], v9 offset:31136
    ds_read_b64_tr_b16 v[18:19], v9 offset:31904
    s_waitcnt lgkmcnt(6)
    v_mfma_f32_32x32x16_bf16 v[64:79], v[24:27], v[152:155], v[64:79]
    ds_read_b64_tr_b16 v[20:21], v9 offset:34048
    ds_read_b64_tr_b16 v[22:23], v9 offset:34816
    s_waitcnt lgkmcnt(6)
    v_mfma_f32_32x32x16_bf16 v[80:95], v[28:31], v[152:155], v[80:95]
    ds_read_b64_tr_b16 v[24:25], v9 offset:34080
    ds_read_b64_tr_b16 v[26:27], v9 offset:34848
    s_waitcnt vmcnt(6)
    s_mov_b64 exec, 1
    ds_add_u32 v4, v3
    s_mov_b64 exec, -1
    s_waitcnt lgkmcnt(7)
    v_mfma_f32_32x32x16_bf16 v[96:111], v[12:15], v[152:155], v[96:111]
    ds_read_b64_tr_b16 v[28:29], v9 offset:34112
    ds_read_b64_tr_b16 v[30:31], v9 offset:34880
    s_waitcnt lgkmcnt(7)
    v_mfma_f32_32x32x16_bf16 v[112:127], v[16:19], v[152:155], v[112:127]
    ds_read_b64_tr_b16 v[12:13], v9 offset:34144
    ds_read_b64_tr_b16 v[14:15], v9 offset:34912
    s_waitcnt lgkmcnt(7)
    v_mfma_f32_32x32x16_bf16 v[32:47], v[20:23], v[156:159], v[32:47]
    ds_read_b64_tr_b16 v[16:17], v9 offset:34176
    ds_read_b64_tr_b16 v[18:19], v9 offset:34944
    s_waitcnt lgkmcnt(7)
    v_mfma_f32_32x32x16_bf16 v[48:63], v[24:27], v[156:159], v[48:63]
    ds_read_b64_tr_b16 v[20:21], v9 offset:34208
    ds_read_b64_tr_b16 v[22:23], v9 offset:34976
    s_mov_b32 s51, 262144
    s_setprio 3
fb_sw2:
    ds_read_b32 v2, v10
    s_waitcnt lgkmcnt(0)
    v_cmp_gt_u32 vcc, 3, v2
    s_cbranch_vccz fb_sw2_ok
    s_sub_u32 s51, s51, 1
    s_cmp_lg_u32 s51, 0
    s_cbranch_scc1 fb_sw2
fb_sw2_ok:
    s_setprio 0
    s_add_u32 m0, s66, 24832
    s_nop 0
    buffer_load_dwordx4 v5, s[32:35], s62 offen offset:0 lds
    v_mfma_f32_32x32x16_bf16 v[64:79], v[28:31], v[156:159], v[64:79]
    ds_read_b64_tr_b16 v[24:25], v9 offset:0
    ds_read_b64_tr_b16 v[26:27], v9 offset:768
    v_mfma_f32_32x32x16_bf16 v[80:95], v[12:15], v[156:159], v[80:95]
    ds_read_b64_tr_b16 v[28:29], v9 offset:32
    ds_read_b64_tr_b16 v[30:31], v9 offset:800
    v_mfma_f32_32x32x16_bf16 v[96:111], v[16:19], v[156:159], v[96:111]
    ds_read_b64_tr_b16 v[12:13], v9 offset:64
    ds_read_b64_tr_b16 v[14:15], v9 offset:832
    buffer_load_dwordx4 v6, s[32:35], s62 offen offset:1024 lds
    v_mfma_f32_32x32x16_bf16 v[112:127], v[20:23], v[156:159], v[112:127]
    ds_read_b64_tr_b16 v[16:17], v9 offset:96
    ds_read_b64_tr_b16 v[18:19], v9 offset:864
    s_waitcnt lgkmcnt(6)
    v_mfma_f32_32x32x16_bf16 v[32:47], v[24:27], v[160:163], v[32:47]
    ds_read_b64_tr_b16 v[20:21], v9 offset:128
    ds_read_b64_tr_b16 v[22:23], v9 offset:896
    s_waitcnt lgkmcnt(6)
    v_mfma_f32_32x32x16_bf16 v[48:63], v[28:31], v[160:163], v[48:63]
    ds_read_b64_tr_b16 v[24:25], v9 offset:160
    ds_read_b64_tr_b16 v[26:27], v9 offset:928
    buffer_load_dwordx4 v7, s[32:35], s62 offen offset:2048 lds
    s_waitcnt lgkmcnt(6)
    v_mfma_f32_32x32x16_bf16 v[64:79], v[12:15], v[160:163], v[64:79]
    ds_read_b64_tr_b16 v[28:29], v9 offset:3072
    ds_read_b64_tr_b16 v[30:31], v9 offset:3840
    s_waitcnt lgkmcnt(6)
    v_mfma_f32_32x32x16_bf16 v[80:95], v[16:19], v[160:163], v[80:95]
    ds_read_b64_tr_b16 v[12:13], v9 offset:3104
    ds_read_b64_tr_b16 v[14:15], v9 offset:3872
    s_waitcnt lgkmcnt(6)
    v_mfma_f32_32x32x16_bf16 v[96:111], v[20:23], v[160:163], v[96:111]
    ds_read_b64_tr_b16 v[16:17], v9 offset:3136
    ds_read_b64_tr_b16 v[18:19], v9 offset:3904
    s_add_u32 m0, s66, 37152
    s_nop 0
    buffer_load_dwordx4 v5, s[36:39], s62 offen offset:0 lds
    s_waitcnt lgkmcnt(6)
    v_mfma_f32_32x32x16_bf16 v[112:127], v[24:27], v[160:163], v[112:127]
    ds_read_b64_tr_b16 v[20:21], v9 offset:3168
    ds_read_b64_tr_b16 v[22:23], v9 offset:3936
    s_waitcnt lgkmcnt(6)
    v_mfma_f32_32x32x16_bf16 v[32:47], v[28:31], v[164:167], v[32:47]
    ds_read_b64_tr_b16 v[24:25], v9 offset:3200
    ds_read_b64_tr_b16 v[26:27], v9 offset:3968
    s_waitcnt lgkmcnt(6)
    v_mfma_f32_32x32x16_bf16 v[48:63], v[12:15], v[164:167], v[48:63]
    ds_read_b64_tr_b16 v[28:29], v9 offset:3232
    ds_read_b64_tr_b16 v[30:31], v9 offset:4000
    buffer_load_dwordx4 v6, s[36:39], s62 offen offset:1024 lds
    s_waitcnt lgkmcnt(6)
    v_mfma_f32_32x32x16_bf16 v[64:79], v[16:19], v[164:167], v[64:79]
    ds_read_b64_tr_b16 v[12:13], v9 offset:6144
    ds_read_b64_tr_b16 v[14:15], v9 offset:6912
    s_waitcnt lgkmcnt(6)
    v_mfma_f32_32x32x16_bf16 v[80:95], v[20:23], v[164:167], v[80:95]
    ds_read_b64_tr_b16 v[16:17], v9 offset:6176
    ds_read_b64_tr_b16 v[18:19], v9 offset:6944
    s_waitcnt lgkmcnt(6)
    v_mfma_f32_32x32x16_bf16 v[96:111], v[24:27], v[164:167], v[96:111]
    ds_read_b64_tr_b16 v[20:21], v9 offset:6208
    ds_read_b64_tr_b16 v[22:23], v9 offset:6976
    buffer_load_dwordx4 v7, s[36:39], s62 offen offset:2048 lds
    s_waitcnt lgkmcnt(6)
    v_mfma_f32_32x32x16_bf16 v[112:127], v[28:31], v[164:167], v[112:127]
    ds_read_b64_tr_b16 v[24:25], v9 offset:6240
    ds_read_b64_tr_b16 v[26:27], v9 offset:7008
    s_waitcnt lgkmcnt(6)
    v_mfma_f32_32x32x16_bf16 v[32:47], v[12:15], v[168:171], v[32:47]
    ds_read_b64_tr_b16 v[28:29], v9 offset:6272
    ds_read_b64_tr_b16 v[30:31], v9 offset:7040
    s_waitcnt lgkmcnt(6)
    v_mfma_f32_32x32x16_bf16 v[48:63], v[16:19], v[168:171], v[48:63]
    ds_read_b64_tr_b16 v[12:13], v9 offset:6304
    ds_read_b64_tr_b16 v[14:15], v9 offset:7072
    s_waitcnt lgkmcnt(6)
    v_mfma_f32_32x32x16_bf16 v[64:79], v[20:23], v[168:171], v[64:79]
    ds_read_b64_tr_b16 v[16:17], v9 offset:9216
    ds_read_b64_tr_b16 v[18:19], v9 offset:9984
    s_waitcnt lgkmcnt(6)
    v_mfma_f32_32x32x16_bf16 v[80:95], v[24:27], v[168:171], v[80:95]
    ds_read_b64_tr_b16 v[20:21], v9 offset:9248
    ds_read_b64_tr_b16 v[22:23], v9 offset:10016
    s_waitcnt vmcnt(6)
    s_mov_b64 exec, 1
    ds_add_u32 v4, v3
    s_mov_b64 exec, -1
    s_waitcnt lgkmcnt(7)
    v_mfma_f32_32x32x16_bf16 v[96:111], v[28:31], v[168:171], v[96:111]
    ds_read_b64_tr_b16 v[24:25], v9 offset:9280
    ds_read_b64_tr_b16 v[26:27], v9 offset:10048
    s_waitcnt lgkmcnt(7)
    v_mfma_f32_32x32x16_bf16 v[112:127], v[12:15], v[168:171], v[112:127]
    ds_read_b64_tr_b16 v[28:29], v9 offset:9312
    ds_read_b64_tr_b16 v[30:31], v9 offset:10080
    s_waitcnt lgkmcnt(7)
    v_mfma_f32_32x32x16_bf16 v[32:47], v[16:19], v[172:175], v[32:47]
    ds_read_b64_tr_b16 v[12:13], v9 offset:9344
    ds_read_b64_tr_b16 v[14:15], v9 offset:10112
    s_waitcnt lgkmcnt(7)
    v_mfma_f32_32x32x16_bf16 v[48:63], v[20:23], v[172:175], v[48:63]
    ds_read_b64_tr_b16 v[16:17], v9 offset:9376
    ds_read_b64_tr_b16 v[18:19], v9 offset:10144
    s_mov_b32 s51, 262144
    s_setprio 3
fb_sw3:
    ds_read_b32 v2, v10
    s_waitcnt lgkmcnt(0)
    v_cmp_gt_u32 vcc, 4, v2
    s_cbranch_vccz fb_sw3_ok
    s_sub_u32 s51, s51, 1
    s_cmp_lg_u32 s51, 0
    s_cbranch_scc1 fb_sw3
fb_sw3_ok:
    s_setprio 0
    s_add_u32 m0, s66, 84224
    s_nop 0
    buffer_load_dwordx4 v5, s[32:35], s63 offen offset:0 lds
    v_mfma_f32_32x32x16_bf16 v[64:79], v[24:27], v[172:175], v[64:79]
    ds_read_b64_tr_b16 v[20:21], v0 offset:0
    ds_read_b64_tr_b16 v[22:23], v0 offset:768
    v_mfma_f32_32x32x16_bf16 v[80:95], v[28:31], v[172:175], v[80:95]
    ds_read_b64_tr_b16 v[24:25], v0 offset:32
    ds_read_b64_tr_b16 v[26:27], v0 offset:800
    v_mfma_f32_32x32x16_bf16 v[96:111], v[12:15], v[172:175], v[96:111]
    ds_read_b64_tr_b16 v[28:29], v0 offset:64
    ds_read_b64_tr_b16 v[30:31], v0 offset:832
    buffer_load_dwordx4 v6, s[32:35], s63 offen offset:1024 lds
    v_mfma_f32_32x32x16_bf16 v[112:127], v[16:19], v[172:175], v[112:127]
    ds_read_b64_tr_b16 v[12:13], v0 offset:96
    ds_read_b64_tr_b16 v[14:15], v0 offset:864
    s_waitcnt lgkmcnt(6)
    v_mfma_f32_32x32x16_bf16 v[32:47], v[20:23], v[176:179], v[32:47]
    ds_read_b64_tr_b16 v[16:17], v0 offset:128
    ds_read_b64_tr_b16 v[18:19], v0 offset:896
    s_waitcnt lgkmcnt(6)
    v_mfma_f32_32x32x16_bf16 v[48:63], v[24:27], v[176:179], v[48:63]
    ds_read_b64_tr_b16 v[20:21], v0 offset:160
    ds_read_b64_tr_b16 v[22:23], v0 offset:928
    buffer_load_dwordx4 v7, s[32:35], s63 offen offset:2048 lds
    s_waitcnt lgkmcnt(6)
    v_mfma_f32_32x32x16_bf16 v[64:79], v[28:31], v[176:179], v[64:79]
    ds_read_b64_tr_b16 v[24:25], v0 offset:3072
    ds_read_b64_tr_b16 v[26:27], v0 offset:3840
    s_waitcnt lgkmcnt(6)
    v_mfma_f32_32x32x16_bf16 v[80:95], v[12:15], v[176:179], v[80:95]
    ds_read_b64_tr_b16 v[28:29], v0 offset:3104
    ds_read_b64_tr_b16 v[30:31], v0 offset:3872
    s_waitcnt lgkmcnt(6)
    v_mfma_f32_32x32x16_bf16 v[96:111], v[16:19], v[176:179], v[96:111]
    ds_read_b64_tr_b16 v[12:13], v0 offset:3136
    ds_read_b64_tr_b16 v[14:15], v0 offset:3904
    s_add_u32 m0, s66, 96544
    s_nop 0
    buffer_load_dwordx4 v5, s[36:39], s63 offen offset:0 lds
    s_waitcnt lgkmcnt(6)
    v_mfma_f32_32x32x16_bf16 v[112:127], v[20:23], v[176:179], v[112:127]
    ds_read_b64_tr_b16 v[16:17], v0 offset:3168
    ds_read_b64_tr_b16 v[18:19], v0 offset:3936
    s_waitcnt lgkmcnt(6)
    v_mfma_f32_32x32x16_bf16 v[32:47], v[24:27], v[180:183], v[32:47]
    ds_read_b64_tr_b16 v[20:21], v0 offset:3200
    ds_read_b64_tr_b16 v[22:23], v0 offset:3968
    s_waitcnt lgkmcnt(6)
    v_mfma_f32_32x32x16_bf16 v[48:63], v[28:31], v[180:183], v[48:63]
    ds_read_b64_tr_b16 v[24:25], v0 offset:3232
    ds_read_b64_tr_b16 v[26:27], v0 offset:4000
    buffer_load_dwordx4 v6, s[36:39], s63 offen offset:1024 lds
    s_waitcnt lgkmcnt(6)
    v_mfma_f32_32x32x16_bf16 v[64:79], v[12:15], v[180:183], v[64:79]
    ds_read_b64_tr_b16 v[28:29], v0 offset:6144
    ds_read_b64_tr_b16 v[30:31], v0 offset:6912
    s_waitcnt lgkmcnt(6)
    v_mfma_f32_32x32x16_bf16 v[80:95], v[16:19], v[180:183], v[80:95]
    ds_read_b64_tr_b16 v[12:13], v0 offset:6176
    ds_read_b64_tr_b16 v[14:15], v0 offset:6944
    s_waitcnt lgkmcnt(6)
    v_mfma_f32_32x32x16_bf16 v[96:111], v[20:23], v[180:183], v[96:111]
    ds_read_b64_tr_b16 v[16:17], v0 offset:6208
    ds_read_b64_tr_b16 v[18:19], v0 offset:6976
    buffer_load_dwordx4 v7, s[36:39], s63 offen offset:2048 lds
    s_waitcnt lgkmcnt(6)
    v_mfma_f32_32x32x16_bf16 v[112:127], v[24:27], v[180:183], v[112:127]
    ds_read_b64_tr_b16 v[20:21], v0 offset:6240
    ds_read_b64_tr_b16 v[22:23], v0 offset:7008
    s_waitcnt lgkmcnt(6)
    v_mfma_f32_32x32x16_bf16 v[32:47], v[28:31], v[184:187], v[32:47]
    ds_read_b64_tr_b16 v[24:25], v0 offset:6272
    ds_read_b64_tr_b16 v[26:27], v0 offset:7040
    s_waitcnt lgkmcnt(6)
    v_mfma_f32_32x32x16_bf16 v[48:63], v[12:15], v[184:187], v[48:63]
    ds_read_b64_tr_b16 v[28:29], v0 offset:6304
    ds_read_b64_tr_b16 v[30:31], v0 offset:7072
    s_waitcnt lgkmcnt(6)
    v_mfma_f32_32x32x16_bf16 v[64:79], v[16:19], v[184:187], v[64:79]
    ds_read_b64_tr_b16 v[12:13], v0 offset:9216
    ds_read_b64_tr_b16 v[14:15], v0 offset:9984
    s_waitcnt lgkmcnt(6)
    v_mfma_f32_32x32x16_bf16 v[80:95], v[20:23], v[184:187], v[80:95]
    ds_read_b64_tr_b16 v[16:17], v0 offset:9248
    ds_read_b64_tr_b16 v[18:19], v0 offset:10016
    s_waitcnt vmcnt(6)
    s_mov_b64 exec, 1
    ds_add_u32 v4, v3
    s_mov_b64 exec, -1
    s_waitcnt lgkmcnt(7)
    v_mfma_f32_32x32x16_bf16 v[96:111], v[24:27], v[184:187], v[96:111]
    ds_read_b64_tr_b16 v[20:21], v0 offset:9280
    ds_read_b64_tr_b16 v[22:23], v0 offset:10048
    s_waitcnt lgkmcnt(7)
    v_mfma_f32_32x32x16_bf16 v[112:127], v[28:31], v[184:187], v[112:127]
    ds_read_b64_tr_b16 v[24:25], v0 offset:9312
    ds_read_b64_tr_b16 v[26:27], v0 offset:10080
    s_waitcnt lgkmcnt(7)
    v_mfma_f32_32x32x16_bf16 v[32:47], v[12:15], v[188:191], v[32:47]
    ds_read_b64_tr_b16 v[28:29], v0 offset:9344
    ds_read_b64_tr_b16 v[30:31], v0 offset:10112
    s_waitcnt lgkmcnt(7)
    v_mfma_f32_32x32x16_bf16 v[48:63], v[16:19], v[188:191], v[48:63]
    ds_read_b64_tr_b16 v[12:13], v0 offset:9376
    ds_read_b64_tr_b16 v[14:15], v0 offset:10144
    s_mov_b32 s51, 262144
    s_setprio 3
fb_sw4:
    ds_read_b32 v2, v10
    s_waitcnt lgkmcnt(0)
    v_cmp_gt_u32 vcc, 5, v2
    s_cbranch_vccz fb_sw4_ok
    s_sub_u32 s51, s51, 1
    s_cmp_lg_u32 s51, 0
    s_cbranch_scc1 fb_sw4
fb_sw4_ok:
    s_setprio 0
    s_add_u32 m0, s66, 59392
    s_nop 0
    buffer_load_dwordx4 v5, s[32:35], s64 offen offset:0 lds
    v_mfma_f32_32x32x16_bf16 v[64:79], v[20:23], v[188:191], v[64:79]
    ds_read_b64_tr_b16 v[16:17], v0 offset:24832
    ds_read_b64_tr_b16 v[18:19], v0 offset:25600
    v_mfma_f32_32x32x16_bf16 v[80:95], v[24:27], v[188:191], v[80:95]
    ds_read_b64_tr_b16 v[20:21], v0 offset:24864
    ds_read_b64_tr_b16 v[22:23], v0 offset:25632
    v_mfma_f32_32x32x16_bf16 v[96:111], v[28:31], v[188:191], v[96:111]
    ds_read_b64_tr_b16 v[24:25], v0 offset:24896
    ds_read_b64_tr_b16 v[26:27], v0 offset:25664
    buffer_load_dwordx4 v6, s[32:35], s64 offen offset:1024 lds
    v_mfma_f32_32x32x16_bf16 v[112:127], v[12:15], v[188:191], v[112:127]
    ds_read_b64_tr_b16 v[28:29], v0 offset:24928
    ds_read_b64_tr_b16 v[30:31], v0 offset:25696
    s_waitcnt lgkmcnt(6)
    v_mfma_f32_32x32x16_bf16 v[32:47], v[16:19], v[192:195], v[32:47]
    ds_read_b64_tr_b16 v[12:13], v0 offset:24960
    ds_read_b64_tr_b16 v[14:15], v0 offset:25728
    s_waitcnt lgkmcnt(6)
    v_mfma_f32_32x32x16_bf16 v[48:63], v[20:23], v[192:195], v[48:63]
    ds_read_b64_tr_b16 v[16:17], v0 offset:24992
    ds_read_b64_tr_b16 v[18:19], v0 offset:25760
    buffer_load_dwordx4 v7, s[32:35], s64 offen offset:2048 lds
    s_waitcnt lgkmcnt(6)
    v_mfma_f32_32x32x16_bf16 v[64:79], v[24:27], v[192:195], v[64:79]
    ds_read_b64_tr_b16 v[20:21], v0 offset:27904
    ds_read_b64_tr_b16 v[22:23], v0 offset:28672
    s_waitcnt lgkmcnt(6)
    v_mfma_f32_32x32x16_bf16 v[80:95], v[28:31], v[192:195], v[80:95]
    ds_read_b64_tr_b16 v[24:25], v0 offset:27936
    ds_read_b64_tr_b16 v[26:27], v0 offset:28704
    s_waitcnt lgkmcnt(6)
    v_mfma_f32_32x32x16_bf16 v[96:111], v[12:15], v[192:195], v[96:111]
    ds_read_b64_tr_b16 v[28:29], v0 offset:27968
    ds_read_b64_tr_b16 v[30:31], v0 offset:28736
    s_add_u32 m0, s66, 71712
    s_nop 0
    buffer_load_dwordx4 v5, s[36:39], s64 offen offset:0 lds
    s_waitcnt lgkmcnt(6)
    v_mfma_f32_32x32x16_bf16 v[112:127], v[16:19], v[192:195], v[112:127]
    ds_read_b64_tr_b16 v[12:13], v0 offset:28000
    ds_read_b64_tr_b16 v[14:15], v0 offset:28768
    s_waitcnt lgkmcnt(6)
    v_mfma_f32_32x32x16_bf16 v[32:47], v[20:23], v[196:199], v[32:47]
    ds_read_b64_tr_b16 v[16:17], v0 offset:28032
    ds_read_b64_tr_b16 v[18:19], v0 offset:28800
    s_waitcnt lgkmcnt(6)
    v_mfma_f32_32x32x16_bf16 v[48:63], v[24:27], v[196:199], v[48:63]
    ds_read_b64_tr_b16 v[20:21], v0 offset:28064
    ds_read_b64_tr_b16 v[22:23], v0 offset:28832
    buffer_load_dwordx4 v6, s[36:39], s64 offen offset:1024 lds
    s_waitcnt lgkmcnt(6)
    v_mfma_f32_32x32x16_bf16 v[64:79], v[28:31], v[196:199], v[64:79]
    ds_read_b64_tr_b16 v[24:25], v0 offset:30976
    ds_read_b64_tr_b16 v[26:27], v0 offset:31744
    s_waitcnt lgkmcnt(6)
    v_mfma_f32_32x32x16_bf16 v[80:95], v[12:15], v[196:199], v[80:95]
    ds_read_b64_tr_b16 v[28:29], v0 offset:31008
    ds_read_b64_tr_b16 v[30:31], v0 offset:31776
    s_waitcnt lgkmcnt(6)
    v_mfma_f32_32x32x16_bf16 v[96:111], v[16:19], v[196:199], v[96:111]
    ds_read_b64_tr_b16 v[12:13], v0 offset:31040
    ds_read_b64_tr_b16 v[14:15], v0 offset:31808
    buffer_load_dwordx4 v7, s[36:39], s64 offen offset:2048 lds
    s_waitcnt lgkmcnt(6)
    v_mfma_f32_32x32x16_bf16 v[112:127], v[20:23], v[196:199], v[112:127]
    ds_read_b64_tr_b16 v[16:17], v0 offset:31072
    ds_read_b64_tr_b16 v[18:19], v0 offset:31840
    s_waitcnt lgkmcnt(6)
    v_mfma_f32_32x32x16_bf16 v[32:47], v[24:27], v[200:203], v[32:47]
    ds_read_b64_tr_b16 v[20:21], v0 offset:31104
    ds_read_b64_tr_b16 v[22:23], v0 offset:31872
    s_waitcnt lgkmcnt(6)
    v_mfma_f32_32x32x16_bf16 v[48:63], v[28:31], v[200:203], v[48:63]
    ds_read_b64_tr_b16 v[24:25], v0 offset:31136
    ds_read_b64_tr_b16 v[26:27], v0 offset:31904
    s_waitcnt lgkmcnt(6)
    v_mfma_f32_32x32x16_bf16 v[64:79], v[12:15], v[200:203], v[64:79]
    ds_read_b64_tr_b16 v[28:29], v0 offset:34048
    ds_read_b64_tr_b16 v[30:31], v0 offset:34816
    s_waitcnt lgkmcnt(6)
    v_mfma_f32_32x32x16_bf16 v[80:95], v[16:19], v[200:203], v[80:95]
    ds_read_b64_tr_b16 v[12:13], v0 offset:34080
    ds_read_b64_tr_b16 v[14:15], v0 offset:34848
    s_waitcnt vmcnt(6)
    s_mov_b64 exec, 1
    ds_add_u32 v4, v3
    s_mov_b64 exec, -1
    s_waitcnt lgkmcnt(7)
    v_mfma_f32_32x32x16_bf16 v[96:111], v[20:23], v[200:203], v[96:111]
    ds_read_b64_tr_b16 v[16:17], v0 offset:34112
    ds_read_b64_tr_b16 v[18:19], v0 offset:34880
    s_waitcnt lgkmcnt(7)
    v_mfma_f32_32x32x16_bf16 v[112:127], v[24:27], v[200:203], v[112:127]
    ds_read_b64_tr_b16 v[20:21], v0 offset:34144
    ds_read_b64_tr_b16 v[22:23], v0 offset:34912
    s_waitcnt lgkmcnt(7)
    v_mfma_f32_32x32x16_bf16 v[32:47], v[28:31], v[204:207], v[32:47]
    ds_read_b64_tr_b16 v[24:25], v0 offset:34176
    ds_read_b64_tr_b16 v[26:27], v0 offset:34944
    s_waitcnt lgkmcnt(7)
    v_mfma_f32_32x32x16_bf16 v[48:63], v[12:15], v[204:207], v[48:63]
    ds_read_b64_tr_b16 v[28:29], v0 offset:34208
    ds_read_b64_tr_b16 v[30:31], v0 offset:34976
    s_mov_b32 s51, 262144
    s_setprio 3
fb_sw5:
    ds_read_b32 v2, v10
    s_waitcnt lgkmcnt(0)
    v_cmp_gt_u32 vcc, 6, v2
    s_cbranch_vccz fb_sw5_ok
    s_sub_u32 s51, s51, 1
    s_cmp_lg_u32 s51, 0
    s_cbranch_scc1 fb_sw5
fb_sw5_ok:
    s_setprio 0
    s_add_u32 m0, s66, 0
    s_nop 0
    buffer_load_dwordx4 v5, s[32:35], s65 offen offset:0 lds
    v_mfma_f32_32x32x16_bf16 v[64:79], v[16:19], v[204:207], v[64:79]
    ds_read_b64_tr_b16 v[12:13], v9 offset:24832
    ds_read_b64_tr_b16 v[14:15], v9 offset:25600
    v_mfma_f32_32x32x16_bf16 v[80:95], v[20:23], v[204:207], v[80:95]
    ds_read_b64_tr_b16 v[16:17], v9 offset:24864
    ds_read_b64_tr_b16 v[18:19], v9 offset:25632
    v_mfma_f32_32x32x16_bf16 v[96:111], v[24:27], v[204:207], v[96:111]
    ds_read_b64_tr_b16 v[20:21], v9 offset:24896
    ds_read_b64_tr_b16 v[22:23], v9 offset:25664
    buffer_load_dwordx4 v6, s[32:35], s65 offen offset:1024 lds
    v_mfma_f32_32x32x16_bf16 v[112:127], v[28:31], v[204:207], v[112:127]
    ds_read_b64_tr_b16 v[24:25], v9 offset:24928
    ds_read_b64_tr_b16 v[26:27], v9 offset:25696
    s_waitcnt lgkmcnt(6)
    v_mfma_f32_32x32x16_bf16 v[32:47], v[12:15], v[208:211], v[32:47]
    ds_read_b64_tr_b16 v[28:29], v9 offset:24960
    ds_read_b64_tr_b16 v[30:31], v9 offset:25728
    s_waitcnt lgkmcnt(6)
    v_mfma_f32_32x32x16_bf16 v[48:63], v[16:19], v[208:211], v[48:63]
    ds_read_b64_tr_b16 v[12:13], v9 offset:24992
    ds_read_b64_tr_b16 v[14:15], v9 offset:25760
    buffer_load_dwordx4 v7, s[32:35], s65 offen offset:2048 lds
    s_waitcnt lgkmcnt(6)
    v_mfma_f32_32x32x16_bf16 v[64:79], v[20:23], v[208:211], v[64:79]
    ds_read_b64_tr_b16 v[16:17], v9 offset:27904
    ds_read_b64_tr_b16 v[18:19], v9 offset:28672
    s_waitcnt lgkmcnt(6)
    v_mfma_f32_32x32x16_bf16 v[80:95], v[24:27], v[208:211], v[80:95]
    ds_read_b64_tr_b16 v[20:21], v9 offset:27936
    ds_read_b64_tr_b16 v[22:23], v9 offset:28704
    s_waitcnt lgkmcnt(6)
    v_mfma_f32_32x32x16_bf16 v[96:111], v[28:31], v[208:211], v[96:111]
    ds_read_b64_tr_b16 v[24:25], v9 offset:27968
    ds_read_b64_tr_b16 v[26:27], v9 offset:28736
    s_add_u32 m0, s66, 12320
    s_nop 0
    buffer_load_dwordx4 v5, s[36:39], s65 offen offset:0 lds
    s_waitcnt lgkmcnt(6)
    v_mfma_f32_32x32x16_bf16 v[112:127], v[12:15], v[208:211], v[112:127]
    ds_read_b64_tr_b16 v[28:29], v9 offset:28000
    ds_read_b64_tr_b16 v[30:31], v9 offset:28768
    s_waitcnt lgkmcnt(6)
    v_mfma_f32_32x32x16_bf16 v[32:47], v[16:19], v[212:215], v[32:47]
    ds_read_b64_tr_b16 v[12:13], v9 offset:28032
    ds_read_b64_tr_b16 v[14:15], v9 offset:28800
    s_waitcnt lgkmcnt(6)
    v_mfma_f32_32x32x16_bf16 v[48:63], v[20:23], v[212:215], v[48:63]
    ds_read_b64_tr_b16 v[16:17], v9 offset:28064
    ds_read_b64_tr_b16 v[18:19], v9 offset:28832
    buffer_load_dwordx4 v6, s[36:39], s65 offen offset:1024 lds
    s_waitcnt lgkmcnt(6)
    v_mfma_f32_32x32x16_bf16 v[64:79], v[24:27], v[212:215], v[64:79]
    ds_read_b64_tr_b16 v[20:21], v9 offset:30976
    ds_read_b64_tr_b16 v[22:23], v9 offset:31744
    s_waitcnt lgkmcnt(6)
    v_mfma_f32_32x32x16_bf16 v[80:95], v[28:31], v[212:215], v[80:95]
    ds_read_b64_tr_b16 v[24:25], v9 offset:31008
    ds_read_b64_tr_b16 v[26:27], v9 offset:31776
    s_waitcnt lgkmcnt(6)
    v_mfma_f32_32x32x16_bf16 v[96:111], v[12:15], v[212:215], v[96:111]
    ds_read_b64_tr_b16 v[28:29], v9 offset:31040
    ds_read_b64_tr_b16 v[30:31], v9 offset:31808
    buffer_load_dwordx4 v7, s[36:39], s65 offen offset:2048 lds
    s_waitcnt lgkmcnt(6)
    v_mfma_f32_32x32x16_bf16 v[112:127], v[16:19], v[212:215], v[112:127]
    ds_read_b64_tr_b16 v[12:13], v9 offset:31072
    ds_read_b64_tr_b16 v[14:15], v9 offset:31840
    s_waitcnt lgkmcnt(6)
    v_mfma_f32_32x32x16_bf16 v[32:47], v[20:23], v[216:219], v[32:47]
    ds_read_b64_tr_b16 v[16:17], v9 offset:31104
    ds_read_b64_tr_b16 v[18:19], v9 offset:31872
    s_waitcnt lgkmcnt(6)
    v_mfma_f32_32x32x16_bf16 v[48:63], v[24:27], v[216:219], v[48:63]
    ds_read_b64_tr_b16 v[20:21], v9 offset:31136
    ds_read_b64_tr_b16 v[22:23], v9 offset:31904
    s_waitcnt lgkmcnt(6)
    v_mfma_f32_32x32x16_bf16 v[64:79], v[28:31], v[216:219], v[64:79]
    ds_read_b64_tr_b16 v[24:25], v9 offset:34048
    ds_read_b64_tr_b16 v[26:27], v9 offset:34816
    s_waitcnt lgkmcnt(6)
    v_mfma_f32_32x32x16_bf16 v[80:95], v[12:15], v[216:219], v[80:95]
    ds_read_b64_tr_b16 v[28:29], v9 offset:34080
    ds_read_b64_tr_b16 v[30:31], v9 offset:34848
    s_waitcnt vmcnt(6)
    s_mov_b64 exec, 1
    ds_add_u32 v4, v3
    s_mov_b64 exec, -1
    s_waitcnt lgkmcnt(7)
    v_mfma_f32_32x32x16_bf16 v[96:111], v[16:19], v[216:219], v[96:111]
    ds_read_b64_tr_b16 v[12:13], v9 offset:34112
    ds_read_b64_tr_b16 v[14:15], v9 offset:34880
    s_waitcnt lgkmcnt(7)
    v_mfma_f32_32x32x16_bf16 v[112:127], v[20:23], v[216:219], v[112:127]
    ds_read_b64_tr_b16 v[16:17], v9 offset:34144
    ds_read_b64_tr_b16 v[18:19], v9 offset:34912
    s_waitcnt lgkmcnt(7)
    v_mfma_f32_32x32x16_bf16 v[32:47], v[24:27], v[220:223], v[32:47]
    ds_read_b64_tr_b16 v[20:21], v9 offset:34176
    ds_read_b64_tr_b16 v[22:23], v9 offset:34944
    s_waitcnt lgkmcnt(7)
    v_mfma_f32_32x32x16_bf16 v[48:63], v[28:31], v[220:223], v[48:63]
    ds_read_b64_tr_b16 v[24:25], v9 offset:34208
    ds_read_b64_tr_b16 v[26:27], v9 offset:34976
    s_mov_b32 s51, 262144
    s_setprio 3
fb_sw6:
    ds_read_b32 v2, v10
    s_waitcnt lgkmcnt(0)
    v_cmp_gt_u32 vcc, 7, v2
    s_cbranch_vccz fb_sw6_ok
    s_sub_u32 s51, s51, 1
    s_cmp_lg_u32 s51, 0
    s_cbranch_scc1 fb_sw6
fb_sw6_ok:
    s_setprio 0
    s_lshr_b32 s47, s2, 3
    s_lshl_b32 s47, s47, 2
    s_add_u32 s47, s47, s3
    v_lshlrev_b32 v5, 7, v1
    s_mov_b32 s32, s16
    s_mov_b32 s33, s17
    s_mov_b32 s34, 1409024
    s_mov_b32 s35, 0x20000
    s_lshl_b32 s47, s47, 13
    buffer_load_dword v128, v5, s[32:35], s47 offen
    v_mfma_f32_32x32x16_bf16 v[64:79], v[12:15], v[220:223], v[64:79]
    ds_read_b64_tr_b16 v[28:29], v9 offset:0
    ds_read_b64_tr_b16 v[30:31], v9 offset:768
    v_mfma_f32_32x32x16_bf16 v[80:95], v[16:19], v[220:223], v[80:95]
    ds_read_b64_tr_b16 v[12:13], v9 offset:32
    ds_read_b64_tr_b16 v[14:15], v9 offset:800
    v_mfma_f32_32x32x16_bf16 v[96:111], v[20:23], v[220:223], v[96:111]
    ds_read_b64_tr_b16 v[16:17], v9 offset:64
    ds_read_b64_tr_b16 v[18:19], v9 offset:832
    v_mfma_f32_32x32x16_bf16 v[112:127], v[24:27], v[220:223], v[112:127]
    ds_read_b64_tr_b16 v[20:21], v9 offset:96
    ds_read_b64_tr_b16 v[22:23], v9 offset:864
    s_waitcnt lgkmcnt(6)
    v_mfma_f32_32x32x16_bf16 v[32:47], v[28:31], v[224:227], v[32:47]
    ds_read_b64_tr_b16 v[24:25], v9 offset:128
    ds_read_b64_tr_b16 v[26:27], v9 offset:896
    s_waitcnt lgkmcnt(6)
    v_mfma_f32_32x32x16_bf16 v[48:63], v[12:15], v[224:227], v[48:63]
    ds_read_b64_tr_b16 v[28:29], v9 offset:160
    ds_read_b64_tr_b16 v[30:31], v9 offset:928
    s_waitcnt lgkmcnt(6)
    v_mfma_f32_32x32x16_bf16 v[64:79], v[16:19], v[224:227], v[64:79]
    ds_read_b64_tr_b16 v[12:13], v9 offset:3072
    ds_read_b64_tr_b16 v[14:15], v9 offset:3840
    s_waitcnt lgkmcnt(6)
    v_mfma_f32_32x32x16_bf16 v[80:95], v[20:23], v[224:227], v[80:95]
    ds_read_b64_tr_b16 v[16:17], v9 offset:3104
    ds_read_b64_tr_b16 v[18:19], v9 offset:3872
    s_waitcnt lgkmcnt(6)
    v_mfma_f32_32x32x16_bf16 v[96:111], v[24:27], v[224:227], v[96:111]
    ds_read_b64_tr_b16 v[20:21], v9 offset:3136
    ds_read_b64_tr_b16 v[22:23], v9 offset:3904
    s_waitcnt lgkmcnt(6)
    v_mfma_f32_32x32x16_bf16 v[112:127], v[28:31], v[224:227], v[112:127]
    ds_read_b64_tr_b16 v[24:25], v9 offset:3168
    ds_read_b64_tr_b16 v[26:27], v9 offset:3936
    s_waitcnt lgkmcnt(6)
    v_mfma_f32_32x32x16_bf16 v[32:47], v[12:15], v[228:231], v[32:47]
    ds_read_b64_tr_b16 v[28:29], v9 offset:3200
    ds_read_b64_tr_b16 v[30:31], v9 offset:3968
    s_waitcnt lgkmcnt(6)
    v_mfma_f32_32x32x16_bf16 v[48:63], v[16:19], v[228:231], v[48:63]
    ds_read_b64_tr_b16 v[12:13], v9 offset:3232
    ds_read_b64_tr_b16 v[14:15], v9 offset:4000
    s_waitcnt lgkmcnt(6)
    v_mfma_f32_32x32x16_bf16 v[64:79], v[20:23], v[228:231], v[64:79]
    ds_read_b64_tr_b16 v[16:17], v9 offset:6144
    ds_read_b64_tr_b16 v[18:19], v9 offset:6912
    s_waitcnt lgkmcnt(6)
    v_mfma_f32_32x32x16_bf16 v[80:95], v[24:27], v[228:231], v[80:95]
    ds_read_b64_tr_b16 v[20:21], v9 offset:6176
    ds_read_b64_tr_b16 v[22:23], v9 offset:6944
    s_waitcnt lgkmcnt(6)
    v_mfma_f32_32x32x16_bf16 v[96:111], v[28:31], v[228:231], v[96:111]
    ds_read_b64_tr_b16 v[24:25], v9 offset:6208
    ds_read_b64_tr_b16 v[26:27], v9 offset:6976
    s_waitcnt lgkmcnt(6)
    v_mfma_f32_32x32x16_bf16 v[112:127], v[12:15], v[228:231], v[112:127]
    ds_read_b64_tr_b16 v[28:29], v9 offset:6240
    ds_read_b64_tr_b16 v[30:31], v9 offset:7008
    s_waitcnt lgkmcnt(6)
    v_mfma_f32_32x32x16_bf16 v[32:47], v[16:19], v[232:235], v[32:47]
    ds_read_b64_tr_b16 v[12:13], v9 offset:6272
    ds_read_b64_tr_b16 v[14:15], v9 offset:7040
    s_waitcnt lgkmcnt(6)
    v_mfma_f32_32x32x16_bf16 v[48:63], v[20:23], v[232:235], v[48:63]
    ds_read_b64_tr_b16 v[16:17], v9 offset:6304
    ds_read_b64_tr_b16 v[18:19], v9 offset:7072
    s_waitcnt lgkmcnt(6)
    v_mfma_f32_32x32x16_bf16 v[64:79], v[24:27], v[232:235], v[64:79]
    ds_read_b64_tr_b16 v[20:21], v9 offset:9216
    ds_read_b64_tr_b16 v[22:23], v9 offset:9984
    s_waitcnt lgkmcnt(6)
    v_mfma_f32_32x32x16_bf16 v[80:95], v[28:31], v[232:235], v[80:95]
    ds_read_b64_tr_b16 v[24:25], v9 offset:9248
    ds_read_b64_tr_b16 v[26:27], v9 offset:10016
    s_waitcnt vmcnt(1)
    s_mov_b64 exec, 1
    ds_add_u32 v4, v3
    s_mov_b64 exec, -1
    s_waitcnt lgkmcnt(7)
    v_mfma_f32_32x32x16_bf16 v[96:111], v[12:15], v[232:235], v[96:111]
    ds_read_b64_tr_b16 v[28:29], v9 offset:9280
    ds_read_b64_tr_b16 v[30:31], v9 offset:10048
    s_waitcnt lgkmcnt(7)
    v_mfma_f32_32x32x16_bf16 v[112:127], v[16:19], v[232:235], v[112:127]
    ds_read_b64_tr_b16 v[12:13], v9 offset:9312
    ds_read_b64_tr_b16 v[14:15], v9 offset:10080
    s_waitcnt lgkmcnt(7)
    v_mfma_f32_32x32x16_bf16 v[32:47], v[20:23], v[236:239], v[32:47]
    ds_read_b64_tr_b16 v[16:17], v9 offset:9344
    ds_read_b64_tr_b16 v[18:19], v9 offset:10112
    s_waitcnt lgkmcnt(7)
    v_mfma_f32_32x32x16_bf16 v[48:63], v[24:27], v[236:239], v[48:63]
    ds_read_b64_tr_b16 v[20:21], v9 offset:9376
    ds_read_b64_tr_b16 v[22:23], v9 offset:10144
    s_mov_b32 s51, 262144
    s_setprio 3
fb_sw7:
    ds_read_b32 v2, v10
    s_waitcnt lgkmcnt(0)
    v_cmp_gt_u32 vcc, 8, v2
    s_cbranch_vccz fb_sw7_ok
    s_sub_u32 s51, s51, 1
    s_cmp_lg_u32 s51, 0
    s_cbranch_scc1 fb_sw7
fb_sw7_ok:
    s_setprio 0
    s_lshr_b32 s47, s2, 3
    s_lshl_b32 s47, s47, 2
    s_add_u32 s47, s47, s3
    v_lshlrev_b32 v5, 7, v1
    s_mov_b32 s36, s8
    s_mov_b32 s37, s9
    s_mov_b32 s38, 524288
    s_mov_b32 s39, 0x20000
    s_mul_i32 s48, s47, 2816
    s_add_u32 s48, s48, 0x100000
    s_lshl_b32 s47, s47, 12
    s_mov_b64 exec, 0x3fffff
    buffer_load_dword v129, v5, s[32:35], s48 offen
    s_mov_b32 exec_lo, -1
    buffer_load_dword v130, v5, s[36:39], s47 offen
    s_mov_b64 exec, -1
    v_mfma_f32_32x32x16_bf16 v[64:79], v[28:31], v[236:239], v[64:79]
    ds_read_b64_tr_b16 v[24:25], v0 offset:0
    ds_read_b64_tr_b16 v[26:27], v0 offset:768
    v_mfma_f32_32x32x16_bf16 v[80:95], v[12:15], v[236:239], v[80:95]
    ds_read_b64_tr_b16 v[28:29], v0 offset:32
    ds_read_b64_tr_b16 v[30:31], v0 offset:800
    v_mfma_f32_32x32x16_bf16 v[96:111], v[16:19], v[236:239], v[96:111]
    ds_read_b64_tr_b16 v[12:13], v0 offset:64
    ds_read_b64_tr_b16 v[14:15], v0 offset:832
    v_mfma_f32_32x32x16_bf16 v[112:127], v[20:23], v[236:239], v[112:127]
    ds_read_b64_tr_b16 v[16:17], v0 offset:96
    ds_read_b64_tr_b16 v[18:19], v0 offset:864
    s_waitcnt lgkmcnt(6)
    v_mfma_f32_32x32x16_bf16 v[32:47], v[24:27], v[240:243], v[32:47]
    ds_read_b64_tr_b16 v[20:21], v0 offset:128
    ds_read_b64_tr_b16 v[22:23], v0 offset:896
    s_waitcnt lgkmcnt(6)
    v_mfma_f32_32x32x16_bf16 v[48:63], v[28:31], v[240:243], v[48:63]
    ds_read_b64_tr_b16 v[24:25], v0 offset:160
    ds_read_b64_tr_b16 v[26:27], v0 offset:928
    s_waitcnt lgkmcnt(6)
    v_mfma_f32_32x32x16_bf16 v[64:79], v[12:15], v[240:243], v[64:79]
    ds_read_b64_tr_b16 v[28:29], v0 offset:3072
    ds_read_b64_tr_b16 v[30:31], v0 offset:3840
    s_waitcnt lgkmcnt(6)
    v_mfma_f32_32x32x16_bf16 v[80:95], v[16:19], v[240:243], v[80:95]
    ds_read_b64_tr_b16 v[12:13], v0 offset:3104
    ds_read_b64_tr_b16 v[14:15], v0 offset:3872
    s_waitcnt lgkmcnt(6)
    v_mfma_f32_32x32x16_bf16 v[96:111], v[20:23], v[240:243], v[96:111]
    ds_read_b64_tr_b16 v[16:17], v0 offset:3136
    ds_read_b64_tr_b16 v[18:19], v0 offset:3904
    s_waitcnt lgkmcnt(6)
    v_mfma_f32_32x32x16_bf16 v[112:127], v[24:27], v[240:243], v[112:127]
    ds_read_b64_tr_b16 v[20:21], v0 offset:3168
    ds_read_b64_tr_b16 v[22:23], v0 offset:3936
    s_waitcnt lgkmcnt(6)
    v_mfma_f32_32x32x16_bf16 v[32:47], v[28:31], v[244:247], v[32:47]
    ds_read_b64_tr_b16 v[24:25], v0 offset:3200
    ds_read_b64_tr_b16 v[26:27], v0 offset:3968
    s_waitcnt lgkmcnt(6)
    v_mfma_f32_32x32x16_bf16 v[48:63], v[12:15], v[244:247], v[48:63]
    ds_read_b64_tr_b16 v[28:29], v0 offset:3232
    ds_read_b64_tr_b16 v[30:31], v0 offset:4000
    s_waitcnt lgkmcnt(6)
    v_mfma_f32_32x32x16_bf16 v[64:79], v[16:19], v[244:247], v[64:79]
    ds_read_b64_tr_b16 v[12:13], v0 offset:6144
    ds_read_b64_tr_b16 v[14:15], v0 offset:6912
    s_waitcnt lgkmcnt(6)
    v_mfma_f32_32x32x16_bf16 v[80:95], v[20:23], v[244:247], v[80:95]
    ds_read_b64_tr_b16 v[16:17], v0 offset:6176
    ds_read_b64_tr_b16 v[18:19], v0 offset:6944
    s_waitcnt lgkmcnt(6)
    v_mfma_f32_32x32x16_bf16 v[96:111], v[24:27], v[244:247], v[96:111]
    ds_read_b64_tr_b16 v[20:21], v0 offset:6208
    ds_read_b64_tr_b16 v[22:23], v0 offset:6976
    s_waitcnt lgkmcnt(6)
    v_mfma_f32_32x32x16_bf16 v[112:127], v[28:31], v[244:247], v[112:127]
    ds_read_b64_tr_b16 v[24:25], v0 offset:6240
    ds_read_b64_tr_b16 v[26:27], v0 offset:7008
    s_waitcnt lgkmcnt(6)
    v_mfma_f32_32x32x16_bf16 v[32:47], v[12:15], v[248:251], v[32:47]
    ds_read_b64_tr_b16 v[28:29], v0 offset:6272
    ds_read_b64_tr_b16 v[30:31], v0 offset:7040
    s_waitcnt lgkmcnt(6)
    v_mfma_f32_32x32x16_bf16 v[48:63], v[16:19], v[248:251], v[48:63]
    ds_read_b64_tr_b16 v[12:13], v0 offset:6304
    ds_read_b64_tr_b16 v[14:15], v0 offset:7072
    s_waitcnt lgkmcnt(6)
    v_mfma_f32_32x32x16_bf16 v[64:79], v[20:23], v[248:251], v[64:79]
    ds_read_b64_tr_b16 v[16:17], v0 offset:9216
    ds_read_b64_tr_b16 v[18:19], v0 offset:9984
    s_waitcnt lgkmcnt(6)
    v_mfma_f32_32x32x16_bf16 v[80:95], v[24:27], v[248:251], v[80:95]
    ds_read_b64_tr_b16 v[20:21], v0 offset:9248
    ds_read_b64_tr_b16 v[22:23], v0 offset:10016
    s_waitcnt lgkmcnt(6)
    v_mfma_f32_32x32x16_bf16 v[96:111], v[28:31], v[248:251], v[96:111]
    ds_read_b64_tr_b16 v[24:25], v0 offset:9280
    ds_read_b64_tr_b16 v[26:27], v0 offset:10048
    s_waitcnt lgkmcnt(6)
    v_mfma_f32_32x32x16_bf16 v[112:127], v[12:15], v[248:251], v[112:127]
    ds_read_b64_tr_b16 v[28:29], v0 offset:9312
    ds_read_b64_tr_b16 v[30:31], v0 offset:10080
    s_waitcnt lgkmcnt(6)
    v_mfma_f32_32x32x16_bf16 v[32:47], v[16:19], v[252:255], v[32:47]
    ds_read_b64_tr_b16 v[12:13], v0 offset:9344
    ds_read_b64_tr_b16 v[14:15], v0 offset:10112
    s_waitcnt lgkmcnt(6)
    v_mfma_f32_32x32x16_bf16 v[48:63], v[20:23], v[252:255], v[48:63]
    ds_read_b64_tr_b16 v[16:17], v0 offset:9376
    ds_read_b64_tr_b16 v[18:19], v0 offset:10144
    s_waitcnt lgkmcnt(6)
    v_mfma_f32_32x32x16_bf16 v[64:79], v[24:27], v[252:255], v[64:79]
    s_waitcnt lgkmcnt(4)
    v_mfma_f32_32x32x16_bf16 v[80:95], v[28:31], v[252:255], v[80:95]
    s_waitcnt lgkmcnt(2)
    v_mfma_f32_32x32x16_bf16 v[96:111], v[12:15], v[252:255], v[96:111]
    s_waitcnt lgkmcnt(0)
    v_mfma_f32_32x32x16_bf16 v[112:127], v[16:19], v[252:255], v[112:127]
    s_setprio 3
    s_mov_b64 exec, 1
    ds_add_u32 v4, v3
    s_mov_b64 exec, -1
    s_lshl_b32 s47, s3, 7
    s_add_u32 s47, s47, 160512
    v_and_b32 v2, 31, v1
    v_lshl_add_u32 v2, v2, 2, s47
    ds_read_b32 v12, v2
    s_waitcnt lgkmcnt(0)
    v_mul_f32 v12, v12, v12
    s_lshl_b32 s67, s44, 2
    s_add_u32 s67, s67, s3
    s_mul_i32 s67, s67, 86
    s_mul_i32 s47, s45, 6
    s_add_u32 s67, s67, s47
    s_lshl_b32 s67, s67, 10
    s_add_u32 s67, s67, 10485760
    s_add_u32 s48, s67, 4096
    v_max_f32 v32, 0, v32
    v_max_f32 v33, 0, v33
    v_max_f32 v34, 0, v34
    v_max_f32 v35, 0, v35
    v_max_f32 v36, 0, v36
    v_max_f32 v37, 0, v37
    v_max_f32 v38, 0, v38
    v_max_f32 v39, 0, v39
    v_pk_mul_f32 v[40:41], v[40:41], v[12:13] op_sel_hi:[1,0]
    v_pk_mul_f32 v[42:43], v[42:43], v[12:13] op_sel_hi:[1,0]
    v_pk_mul_f32 v[44:45], v[44:45], v[12:13] op_sel_hi:[1,0]
    v_pk_mul_f32 v[46:47], v[46:47], v[12:13] op_sel_hi:[1,0]
    v_pk_mul_f32 v[32:33], v[32:33], v[40:41]
    v_pk_mul_f32 v[34:35], v[34:35], v[42:43]
    v_pk_mul_f32 v[36:37], v[36:37], v[44:45]
    v_pk_mul_f32 v[38:39], v[38:39], v[46:47]
    v_cvt_pk_bf16_f32 v32, v32, v33
    v_cvt_pk_bf16_f32 v33, v34, v35
    v_cvt_pk_bf16_f32 v34, v36, v37
    v_cvt_pk_bf16_f32 v35, v38, v39
    buffer_store_dwordx4 v[32:35], v11, s[28:31], s67 offen offset:0 sc1
    v_max_f32 v48, 0, v48
    v_max_f32 v49, 0, v49
    v_max_f32 v50, 0, v50
    v_max_f32 v51, 0, v51
    v_max_f32 v52, 0, v52
    v_max_f32 v53, 0, v53
    v_max_f32 v54, 0, v54
    v_max_f32 v55, 0, v55
    v_pk_mul_f32 v[56:57], v[56:57], v[12:13] op_sel_hi:[1,0]
    v_pk_mul_f32 v[58:59], v[58:59], v[12:13] op_sel_hi:[1,0]
    v_pk_mul_f32 v[60:61], v[60:61], v[12:13] op_sel_hi:[1,0]
    v_pk_mul_f32 v[62:63], v[62:63], v[12:13] op_sel_hi:[1,0]
    v_pk_mul_f32 v[48:49], v[48:49], v[56:57]
    v_pk_mul_f32 v[50:51], v[50:51], v[58:59]
    v_pk_mul_f32 v[52:53], v[52:53], v[60:61]
    v_pk_mul_f32 v[54:55], v[54:55], v[62:63]
    v_cvt_pk_bf16_f32 v48, v48, v49
    v_cvt_pk_bf16_f32 v49, v50, v51
    v_cvt_pk_bf16_f32 v50, v52, v53
    v_cvt_pk_bf16_f32 v51, v54, v55
    buffer_store_dwordx4 v[48:51], v11, s[28:31], s67 offen offset:1024 sc1
    s_cmp_eq_u32 s45, 14
    s_cbranch_scc1 fb_h_done
    v_max_f32 v64, 0, v64
    v_max_f32 v65, 0, v65
    v_max_f32 v66, 0, v66
    v_max_f32 v67, 0, v67
    v_max_f32 v68, 0, v68
    v_max_f32 v69, 0, v69
    v_max_f32 v70, 0, v70
    v_max_f32 v71, 0, v71
    v_pk_mul_f32 v[72:73], v[72:73], v[12:13] op_sel_hi:[1,0]
    v_pk_mul_f32 v[74:75], v[74:75], v[12:13] op_sel_hi:[1,0]
    v_pk_mul_f32 v[76:77], v[76:77], v[12:13] op_sel_hi:[1,0]
    v_pk_mul_f32 v[78:79], v[78:79], v[12:13] op_sel_hi:[1,0]
    v_pk_mul_f32 v[64:65], v[64:65], v[72:73]
    v_pk_mul_f32 v[66:67], v[66:67], v[74:75]
    v_pk_mul_f32 v[68:69], v[68:69], v[76:77]
    v_pk_mul_f32 v[70:71], v[70:71], v[78:79]
    v_cvt_pk_bf16_f32 v64, v64, v65
    v_cvt_pk_bf16_f32 v65, v66, v67
    v_cvt_pk_bf16_f32 v66, v68, v69
    v_cvt_pk_bf16_f32 v67, v70, v71
    buffer_store_dwordx4 v[64:67], v11, s[28:31], s67 offen offset:2048 sc1
    v_max_f32 v80, 0, v80
    v_max_f32 v81, 0, v81
    v_max_f32 v82, 0, v82
    v_max_f32 v83, 0, v83
    v_max_f32 v84, 0, v84
    v_max_f32 v85, 0, v85
    v_max_f32 v86, 0, v86
    v_max_f32 v87, 0, v87
    v_pk_mul_f32 v[88:89], v[88:89], v[12:13] op_sel_hi:[1,0]
    v_pk_mul_f32 v[90:91], v[90:91], v[12:13] op_sel_hi:[1,0]
    v_pk_mul_f32 v[92:93], v[92:93], v[12:13] op_sel_hi:[1,0]
    v_pk_mul_f32 v[94:95], v[94:95], v[12:13] op_sel_hi:[1,0]
    v_pk_mul_f32 v[80:81], v[80:81], v[88:89]
    v_pk_mul_f32 v[82:83], v[82:83], v[90:91]
    v_pk_mul_f32 v[84:85], v[84:85], v[92:93]
    v_pk_mul_f32 v[86:87], v[86:87], v[94:95]
    v_cvt_pk_bf16_f32 v80, v80, v81
    v_cvt_pk_bf16_f32 v81, v82, v83
    v_cvt_pk_bf16_f32 v82, v84, v85
    v_cvt_pk_bf16_f32 v83, v86, v87
    buffer_store_dwordx4 v[80:83], v11, s[28:31], s67 offen offset:3072 sc1
    v_max_f32 v96, 0, v96
    v_max_f32 v97, 0, v97
    v_max_f32 v98, 0, v98
    v_max_f32 v99, 0, v99
    v_max_f32 v100, 0, v100
    v_max_f32 v101, 0, v101
    v_max_f32 v102, 0, v102
    v_max_f32 v103, 0, v103
    v_pk_mul_f32 v[104:105], v[104:105], v[12:13] op_sel_hi:[1,0]
    v_pk_mul_f32 v[106:107], v[106:107], v[12:13] op_sel_hi:[1,0]
    v_pk_mul_f32 v[108:109], v[108:109], v[12:13] op_sel_hi:[1,0]
    v_pk_mul_f32 v[110:111], v[110:111], v[12:13] op_sel_hi:[1,0]
    v_pk_mul_f32 v[96:97], v[96:97], v[104:105]
    v_pk_mul_f32 v[98:99], v[98:99], v[106:107]
    v_pk_mul_f32 v[100:101], v[100:101], v[108:109]
    v_pk_mul_f32 v[102:103], v[102:103], v[110:111]
    v_cvt_pk_bf16_f32 v96, v96, v97
    v_cvt_pk_bf16_f32 v97, v98, v99
    v_cvt_pk_bf16_f32 v98, v100, v101
    v_cvt_pk_bf16_f32 v99, v102, v103
    buffer_store_dwordx4 v[96:99], v11, s[28:31], s48 offen offset:0 sc1
    v_max_f32 v112, 0, v112
    v_max_f32 v113, 0, v113
    v_max_f32 v114, 0, v114
    v_max_f32 v115, 0, v115
    v_max_f32 v116, 0, v116
    v_max_f32 v117, 0, v117
    v_max_f32 v118, 0, v118
    v_max_f32 v119, 0, v119
    v_pk_mul_f32 v[120:121], v[120:121], v[12:13] op_sel_hi:[1,0]
    v_pk_mul_f32 v[122:123], v[122:123], v[12:13] op_sel_hi:[1,0]
    v_pk_mul_f32 v[124:125], v[124:125], v[12:13] op_sel_hi:[1,0]
    v_pk_mul_f32 v[126:127], v[126:127], v[12:13] op_sel_hi:[1,0]
    v_pk_mul_f32 v[112:113], v[112:113], v[120:121]
    v_pk_mul_f32 v[114:115], v[114:115], v[122:123]
    v_pk_mul_f32 v[116:117], v[116:117], v[124:125]
    v_pk_mul_f32 v[118:119], v[118:119], v[126:127]
    v_cvt_pk_bf16_f32 v112, v112, v113
    v_cvt_pk_bf16_f32 v113, v114, v115
    v_cvt_pk_bf16_f32 v114, v116, v117
    v_cvt_pk_bf16_f32 v115, v118, v119
    buffer_store_dwordx4 v[112:115], v11, s[28:31], s48 offen offset:1024 sc1
    s_branch fb_h_done
fb_gu_skip:
    v_mov_b32 v3, 9
    s_lshr_b32 s47, s2, 3
    s_lshl_b32 s47, s47, 2
    s_add_u32 s47, s47, s3
    v_lshlrev_b32 v5, 7, v1
    s_mov_b32 s32, s16
    s_mov_b32 s33, s17
    s_mov_b32 s34, 1409024
    s_mov_b32 s35, 0x20000
    s_lshl_b32 s47, s47, 13
    buffer_load_dword v128, v5, s[32:35], s47 offen
    s_lshr_b32 s47, s2, 3
    s_lshl_b32 s47, s47, 2
    s_add_u32 s47, s47, s3
    v_lshlrev_b32 v5, 7, v1
    s_mov_b32 s36, s8
    s_mov_b32 s37, s9
    s_mov_b32 s38, 524288
    s_mov_b32 s39, 0x20000
    s_mul_i32 s48, s47, 2816
    s_add_u32 s48, s48, 0x100000
    s_lshl_b32 s47, s47, 12
    s_mov_b64 exec, 0x3fffff
    buffer_load_dword v129, v5, s[32:35], s48 offen
    s_mov_b32 exec_lo, -1
    buffer_load_dword v130, v5, s[36:39], s47 offen
    s_mov_b64 exec, -1
    s_mov_b64 exec, 1
    ds_add_u32 v4, v3
    s_mov_b64 exec, -1
fb_h_done:
    s_mov_b32 s51, 262144
    s_setprio 3
fb_sw8:
    ds_read_b32 v2, v10
    s_waitcnt lgkmcnt(0)
    v_cmp_gt_u32 vcc, 9, v2
    s_cbranch_vccz fb_sw8_ok
    s_sub_u32 s51, s51, 1
    s_cmp_lg_u32 s51, 0
    s_cbranch_scc1 fb_sw8
fb_sw8_ok:
    s_setprio 3
    s_mov_b32 s32, s16
    s_mov_b32 s33, s17
    s_mov_b32 s34, 1409024
    s_mov_b32 s35, 0x20000
    s_mov_b32 s36, s8
    s_mov_b32 s37, s9
    s_mov_b32 s38, 524288
    s_mov_b32 s39, 0x20000
    s_and_b32 s71, s2, 7
    s_lshl_b32 s71, s71, 2
    s_bfe_u32 s47, s2, 0x20003
    s_add_u32 s71, s71, s47
    s_lshr_b32 s72, s2, 5
    s_lshl_b32 s47, s47, 1
    s_add_u32 s47, s47, s72
    s_mul_i32 s68, s47, 3
    s_cmp_ge_u32 s68, 22
    s_cselect_b32 s47, 22, 0
    s_sub_u32 s68, s68, s47
    s_mov_b32 s67, s68
    s_mul_i32 s66, s3, 26624
    s_mul_i32 s69, s3, 360448
    s_lshl_b32 s47, s72, 7
    s_add_u32 s69, s69, s47
    s_mul_i32 s70, s3, 22
    s_sub_u32 s73, 85, s70
    s_mul_i32 s47, s71, 172
    s_add_u32 s70, s70, s47
    s_lshl_b32 s70, s70, 10
    s_add_u32 s70, s70, 10485760
    v_bfe_u32 v2, v1, 4, 1
    v_lshlrev_b32 v2, 2, v2
    v_and_b32 v3, 7, v1
    v_xor_b32 v2, v2, v3
    v_lshlrev_b32 v2, 4, v2
    v_lshrrev_b32 v3, 3, v1
    v_lshl_add_u32 v5, v3, 10, v2
    v_add_u32 v6, 7168, v5
    s_add_u32 m0, s66, 0
    s_lshl_b32 s47, s68, 14
    s_add_u32 s47, s47, s69
    s_add_u32 s68, s68, 1
    s_cmp_eq_u32 s68, 22
    s_cselect_b32 s68, 0, s68
    buffer_load_dwordx4 v5, s[32:35], s47 offen offset:0 lds
    buffer_load_dwordx4 v6, s[32:35], s47 offen offset:1024 lds
    s_add_u32 m0, s66, 2048
    s_lshl_b32 s47, s68, 14
    s_add_u32 s47, s47, s69
    s_add_u32 s68, s68, 1
    s_cmp_eq_u32 s68, 22
    s_cselect_b32 s68, 0, s68
    buffer_load_dwordx4 v5, s[32:35], s47 offen offset:0 lds
    buffer_load_dwordx4 v6, s[32:35], s47 offen offset:1024 lds
    s_add_u32 m0, s66, 4096
    s_lshl_b32 s47, s68, 14
    s_add_u32 s47, s47, s69
    s_add_u32 s68, s68, 1
    s_cmp_eq_u32 s68, 22
    s_cselect_b32 s68, 0, s68
    buffer_load_dwordx4 v5, s[32:35], s47 offen offset:0 lds
    buffer_load_dwordx4 v6, s[32:35], s47 offen offset:1024 lds
    s_add_u32 m0, s66, 6144
    s_lshl_b32 s47, s68, 14
    s_add_u32 s47, s47, s69
    s_add_u32 s68, s68, 1
    s_cmp_eq_u32 s68, 22
    s_cselect_b32 s68, 0, s68
    buffer_load_dwordx4 v5, s[32:35], s47 offen offset:0 lds
    buffer_load_dwordx4 v6, s[32:35], s47 offen offset:1024 lds
    s_waitcnt vmcnt(8)
    s_lshl_b32 s47, s3, 2
    s_add_u32 s47, s47, s52
    v_mov_b32 v2, 0
    v_mov_b32 v3, 1
    s_mov_b64 exec, 1
    buffer_store_dword v3, v2, s[28:31], s47 offen offset:16 sc1
    s_mov_b64 exec, -1
    v_lshrrev_b32 v2, 5, v1
    v_lshlrev_b32 v2, 2, v2
    v_bfe_u32 v3, v1, 2, 2
    v_add_u32 v2, v2, v3
    v_lshlrev_b32 v2, 7, v2
    v_bfe_u32 v3, v1, 3, 1
    v_lshl_add_u32 v2, v3, 6, v2
    v_and_b32 v3, 1, v1
    v_lshl_add_u32 v2, v3, 5, v2
    v_bfe_u32 v3, v1, 4, 1
    v_lshl_add_u32 v2, v3, 4, v2
    v_bfe_u32 v3, v1, 1, 1
    v_lshl_add_u32 v8, v3, 3, v2
    s_and_b32 s47, s3, 1
    s_lshl_b32 s47, s47, 6
    v_xor_b32 v8, s47, v8
    v_add_u32 v8, s66, v8
    v_xor_b32 v9, 64, v8
    s_lshr_b32 s47, s3, 1
    s_mul_i32 s48, s47, 88064
    v_add_u32 v104, s48, v11
    s_sub_u32 s48, 88064, s48
    v_add_u32 v105, s48, v11
    s_lshl_b32 s48, s47, 15
    v_add_u32 v106, s48, v11
    v_xor_b32 v107, 0x8000, v106
    s_lshr_b32 s47, s71, 1
    s_lshl_b32 s47, s47, 11
    s_and_b32 s48, s71, 1
    s_lshl_b32 s48, s48, 3
    s_add_u32 s47, s47, s48
    s_add_u32 s47, s47, 20971536
    v_and_b32 v3, 1, v1
    v_lshl_add_u32 v3, v3, 2, s47
    v_bfe_u32 v2, v1, 1, 4
    s_mul_i32 s47, s3, 946
    s_lshr_b32 s47, s47, 8
    s_add_u32 s48, s47, 4
    v_max_u32 v108, s47, v2
    v_min_u32 v108, s48, v108
    v_lshl_add_u32 v108, v108, 7, v3
    v_and_b32 v2, 3, v2
    v_lshl_add_u32 v3, v2, 7, v3
    s_lshl_b32 s47, s3, 9
    s_add_u32 s47, s47, 16
    v_add_u32 v109, s47, v3
    v_and_b32 v2, 31, v1
    v_lshlrev_b32 v2, 10, v2
    v_lshrrev_b32 v3, 5, v1
    v_lshl_add_u32 v110, v3, 5, v2
    s_waitcnt vmcnt(7)
    s_add_u32 m0, s66, 8192
    s_lshl_b32 s47, s68, 14
    s_add_u32 s47, s47, s69
    s_add_u32 s68, s68, 1
    s_cmp_eq_u32 s68, 22
    s_cselect_b32 s68, 0, s68
    buffer_load_dwordx4 v5, s[32:35], s47 offen offset:0 lds
    buffer_load_dwordx4 v6, s[32:35], s47 offen offset:1024 lds
    s_waitcnt vmcnt(7)
    s_add_u32 m0, s66, 10240
    s_lshl_b32 s47, s68, 14
    s_add_u32 s47, s47, s69
    s_add_u32 s68, s68, 1
    s_cmp_eq_u32 s68, 22
    s_cselect_b32 s68, 0, s68
    buffer_load_dwordx4 v5, s[32:35], s47 offen offset:0 lds
    buffer_load_dwordx4 v6, s[32:35], s47 offen offset:1024 lds
    s_waitcnt vmcnt(7)
    s_add_u32 m0, s66, 12288
    s_lshl_b32 s47, s68, 14
    s_add_u32 s47, s47, s69
    s_add_u32 s68, s68, 1
    s_cmp_eq_u32 s68, 22
    s_cselect_b32 s68, 0, s68
    buffer_load_dwordx4 v5, s[32:35], s47 offen offset:0 lds
    buffer_load_dwordx4 v6, s[32:35], s47 offen offset:1024 lds
    s_waitcnt vmcnt(7)
    s_add_u32 m0, s66, 14336
    s_lshl_b32 s47, s68, 14
    s_add_u32 s47, s47, s69
    s_add_u32 s68, s68, 1
    s_cmp_eq_u32 s68, 22
    s_cselect_b32 s68, 0, s68
    buffer_load_dwordx4 v5, s[32:35], s47 offen offset:0 lds
    buffer_load_dwordx4 v6, s[32:35], s47 offen offset:1024 lds
    s_waitcnt vmcnt(6)
    s_add_u32 m0, s66, 16384
    s_lshl_b32 s47, s68, 14
    s_add_u32 s47, s47, s69
    s_add_u32 s68, s68, 1
    s_cmp_eq_u32 s68, 22
    s_cselect_b32 s68, 0, s68
    buffer_load_dwordx4 v5, s[32:35], s47 offen offset:0 lds
    buffer_load_dwordx4 v6, s[32:35], s47 offen offset:1024 lds
    s_waitcnt vmcnt(6)
    s_add_u32 m0, s66, 18432
    s_lshl_b32 s47, s68, 14
    s_add_u32 s47, s47, s69
    s_add_u32 s68, s68, 1
    s_cmp_eq_u32 s68, 22
    s_cselect_b32 s68, 0, s68
    buffer_load_dwordx4 v5, s[32:35], s47 offen offset:0 lds
    buffer_load_dwordx4 v6, s[32:35], s47 offen offset:1024 lds
    s_waitcnt vmcnt(6)
    s_add_u32 m0, s66, 20480
    s_lshl_b32 s47, s68, 14
    s_add_u32 s47, s47, s69
    s_add_u32 s68, s68, 1
    s_cmp_eq_u32 s68, 22
    s_cselect_b32 s68, 0, s68
    buffer_load_dwordx4 v5, s[32:35], s47 offen offset:0 lds
    buffer_load_dwordx4 v6, s[32:35], s47 offen offset:1024 lds
    s_waitcnt vmcnt(6)
    s_add_u32 m0, s66, 22528
    s_lshl_b32 s47, s68, 14
    s_add_u32 s47, s47, s69
    s_add_u32 s68, s68, 1
    s_cmp_eq_u32 s68, 22
    s_cselect_b32 s68, 0, s68
    buffer_load_dwordx4 v5, s[32:35], s47 offen offset:0 lds
    buffer_load_dwordx4 v6, s[32:35], s47 offen offset:1024 lds
    s_waitcnt vmcnt(6)
    s_add_u32 m0, s66, 24576
    s_lshl_b32 s47, s68, 14
    s_add_u32 s47, s47, s69
    s_add_u32 s68, s68, 1
    s_cmp_eq_u32 s68, 22
    s_cselect_b32 s68, 0, s68
    buffer_load_dwordx4 v5, s[32:35], s47 offen offset:0 lds
    buffer_load_dwordx4 v6, s[32:35], s47 offen offset:1024 lds
    s_mov_b32 s51, 32768
fb_h:
    buffer_load_dword v4, v108, s[28:31], 0 offen sc1
fb_h_chk:
    s_waitcnt vmcnt(0)
    v_cmp_ne_u32 vcc, 1, v4
    s_cbranch_vccz fb_h_ok
    s_sub_u32 s51, s51, 1
    s_cmp_lg_u32 s51, 0
    s_cbranch_scc1 fb_h
fb_h_ok:
    s_setprio 0
    s_min_u32 s47, s67, s73
    s_lshl_b32 s47, s47, 10
    s_add_u32 s47, s47, s70
    s_add_u32 s67, s67, 1
    s_cmp_eq_u32 s67, 22
    s_cselect_b32 s67, 0, s67
    buffer_load_dwordx4 v[128:131], v104, s[28:31], s47 offen sc1
    buffer_load_dwordx4 v[132:135], v105, s[28:31], s47 offen sc1
    s_min_u32 s47, s67, s73
    s_lshl_b32 s47, s47, 10
    s_add_u32 s47, s47, s70
    s_add_u32 s67, s67, 1
    s_cmp_eq_u32 s67, 22
    s_cselect_b32 s67, 0, s67
    buffer_load_dwordx4 v[136:139], v104, s[28:31], s47 offen sc1
    buffer_load_dwordx4 v[140:143], v105, s[28:31], s47 offen sc1
    s_min_u32 s47, s67, s73
    s_lshl_b32 s47, s47, 10
    s_add_u32 s47, s47, s70
    s_add_u32 s67, s67, 1
    s_cmp_eq_u32 s67, 22
    s_cselect_b32 s67, 0, s67
    buffer_load_dwordx4 v[144:147], v104, s[28:31], s47 offen sc1
    buffer_load_dwordx4 v[148:151], v105, s[28:31], s47 offen sc1
    s_min_u32 s47, s67, s73
    s_lshl_b32 s47, s47, 10
    s_add_u32 s47, s47, s70
    s_add_u32 s67, s67, 1
    s_cmp_eq_u32 s67, 22
    s_cselect_b32 s67, 0, s67
    buffer_load_dwordx4 v[152:155], v104, s[28:31], s47 offen sc1
    buffer_load_dwordx4 v[156:159], v105, s[28:31], s47 offen sc1
    ds_read_b64_tr_b16 v[12:13], v8 offset:0
    ds_read_b64_tr_b16 v[14:15], v8 offset:1024
    ds_read_b64_tr_b16 v[16:17], v9 offset:0
    ds_read_b64_tr_b16 v[18:19], v9 offset:1024
    ds_read_b64_tr_b16 v[20:21], v8 offset:2048
    ds_read_b64_tr_b16 v[22:23], v8 offset:3072
    ds_read_b64_tr_b16 v[24:25], v9 offset:2048
    ds_read_b64_tr_b16 v[26:27], v9 offset:3072
    s_waitcnt vmcnt(6) lgkmcnt(4)
    v_mfma_f32_32x32x16_bf16 v[32:47], v[12:15], v[128:131], 0
    v_mfma_f32_32x32x16_bf16 v[48:63], v[16:19], v[128:131], 0
    s_min_u32 s47, s67, s73
    s_lshl_b32 s47, s47, 10
    s_add_u32 s47, s47, s70
    s_add_u32 s67, s67, 1
    s_cmp_eq_u32 s67, 22
    s_cselect_b32 s67, 0, s67
    buffer_load_dwordx4 v[160:163], v104, s[28:31], s47 offen sc1
    buffer_load_dwordx4 v[164:167], v105, s[28:31], s47 offen sc1
    v_mfma_f32_32x32x16_bf16 v[64:79], v[12:15], v[132:135], 0
    v_mfma_f32_32x32x16_bf16 v[80:95], v[16:19], v[132:135], 0
    s_add_u32 m0, s66, 0
    s_lshl_b32 s47, s68, 14
    s_add_u32 s47, s47, s69
    s_add_u32 s68, s68, 1
    s_cmp_eq_u32 s68, 22
    s_cselect_b32 s68, 0, s68
    buffer_load_dwordx4 v5, s[32:35], s47 offen offset:0 lds
    buffer_load_dwordx4 v6, s[32:35], s47 offen offset:1024 lds
    ds_read_b64_tr_b16 v[12:13], v8 offset:4096
    ds_read_b64_tr_b16 v[14:15], v8 offset:5120
    ds_read_b64_tr_b16 v[16:17], v9 offset:4096
    ds_read_b64_tr_b16 v[18:19], v9 offset:5120
    s_waitcnt vmcnt(8) lgkmcnt(4)
    v_mfma_f32_32x32x16_bf16 v[32:47], v[20:23], v[136:139], v[32:47]
    v_mfma_f32_32x32x16_bf16 v[48:63], v[24:27], v[136:139], v[48:63]
    s_min_u32 s47, s67, s73
    s_lshl_b32 s47, s47, 10
    s_add_u32 s47, s47, s70
    s_add_u32 s67, s67, 1
    s_cmp_eq_u32 s67, 22
    s_cselect_b32 s67, 0, s67
    buffer_load_dwordx4 v[168:171], v104, s[28:31], s47 offen sc1
    buffer_load_dwordx4 v[172:175], v105, s[28:31], s47 offen sc1
    v_mfma_f32_32x32x16_bf16 v[64:79], v[20:23], v[140:143], v[64:79]
    v_mfma_f32_32x32x16_bf16 v[80:95], v[24:27], v[140:143], v[80:95]
    s_add_u32 m0, s66, 2048
    s_lshl_b32 s47, s68, 14
    s_add_u32 s47, s47, s69
    s_add_u32 s68, s68, 1
    s_cmp_eq_u32 s68, 22
    s_cselect_b32 s68, 0, s68
    buffer_load_dwordx4 v5, s[32:35], s47 offen offset:0 lds
    buffer_load_dwordx4 v6, s[32:35], s47 offen offset:1024 lds
    ds_read_b64_tr_b16 v[20:21], v8 offset:6144
    ds_read_b64_tr_b16 v[22:23], v8 offset:7168
    ds_read_b64_tr_b16 v[24:25], v9 offset:6144
    ds_read_b64_tr_b16 v[26:27], v9 offset:7168
    s_waitcnt vmcnt(10) lgkmcnt(4)
    v_mfma_f32_32x32x16_bf16 v[32:47], v[12:15], v[144:147], v[32:47]
    v_mfma_f32_32x32x16_bf16 v[48:63], v[16:19], v[144:147], v[48:63]
    s_min_u32 s47, s67, s73
    s_lshl_b32 s47, s47, 10
    s_add_u32 s47, s47, s70
    s_add_u32 s67, s67, 1
    s_cmp_eq_u32 s67, 22
    s_cselect_b32 s67, 0, s67
    buffer_load_dwordx4 v[176:179], v104, s[28:31], s47 offen sc1
    buffer_load_dwordx4 v[180:183], v105, s[28:31], s47 offen sc1
    v_mfma_f32_32x32x16_bf16 v[64:79], v[12:15], v[148:151], v[64:79]
    v_mfma_f32_32x32x16_bf16 v[80:95], v[16:19], v[148:151], v[80:95]
    s_add_u32 m0, s66, 4096
    s_lshl_b32 s47, s68, 14
    s_add_u32 s47, s47, s69
    s_add_u32 s68, s68, 1
    s_cmp_eq_u32 s68, 22
    s_cselect_b32 s68, 0, s68
    buffer_load_dwordx4 v5, s[32:35], s47 offen offset:0 lds
    buffer_load_dwordx4 v6, s[32:35], s47 offen offset:1024 lds
    ds_read_b64_tr_b16 v[12:13], v8 offset:8192
    ds_read_b64_tr_b16 v[14:15], v8 offset:9216
    ds_read_b64_tr_b16 v[16:17], v9 offset:8192
    ds_read_b64_tr_b16 v[18:19], v9 offset:9216
    s_waitcnt vmcnt(12) lgkmcnt(4)
    v_mfma_f32_32x32x16_bf16 v[32:47], v[20:23], v[152:155], v[32:47]
    v_mfma_f32_32x32x16_bf16 v[48:63], v[24:27], v[152:155], v[48:63]
    s_min_u32 s47, s67, s73
    s_lshl_b32 s47, s47, 10
    s_add_u32 s47, s47, s70
    s_add_u32 s67, s67, 1
    s_cmp_eq_u32 s67, 22
    s_cselect_b32 s67, 0, s67
    buffer_load_dwordx4 v[184:187], v104, s[28:31], s47 offen sc1
    buffer_load_dwordx4 v[188:191], v105, s[28:31], s47 offen sc1
    v_mfma_f32_32x32x16_bf16 v[64:79], v[20:23], v[156:159], v[64:79]
    v_mfma_f32_32x32x16_bf16 v[80:95], v[24:27], v[156:159], v[80:95]
    s_add_u32 m0, s66, 6144
    s_lshl_b32 s47, s68, 14
    s_add_u32 s47, s47, s69
    s_add_u32 s68, s68, 1
    s_cmp_eq_u32 s68, 22
    s_cselect_b32 s68, 0, s68
    buffer_load_dwordx4 v5, s[32:35], s47 offen offset:0 lds
    buffer_load_dwordx4 v6, s[32:35], s47 offen offset:1024 lds
    ds_read_b64_tr_b16 v[20:21], v8 offset:10240
    ds_read_b64_tr_b16 v[22:23], v8 offset:11264
    ds_read_b64_tr_b16 v[24:25], v9 offset:10240
    ds_read_b64_tr_b16 v[26:27], v9 offset:11264
    s_waitcnt vmcnt(14) lgkmcnt(4)
    v_mfma_f32_32x32x16_bf16 v[32:47], v[12:15], v[160:163], v[32:47]
    v_mfma_f32_32x32x16_bf16 v[48:63], v[16:19], v[160:163], v[48:63]
    s_min_u32 s47, s67, s73
    s_lshl_b32 s47, s47, 10
    s_add_u32 s47, s47, s70
    s_add_u32 s67, s67, 1
    s_cmp_eq_u32 s67, 22
    s_cselect_b32 s67, 0, s67
    buffer_load_dwordx4 v[128:131], v104, s[28:31], s47 offen sc1
    buffer_load_dwordx4 v[132:135], v105, s[28:31], s47 offen sc1
    v_mfma_f32_32x32x16_bf16 v[64:79], v[12:15], v[164:167], v[64:79]
    v_mfma_f32_32x32x16_bf16 v[80:95], v[16:19], v[164:167], v[80:95]
    s_add_u32 m0, s66, 8192
    s_lshl_b32 s47, s68, 14
    s_add_u32 s47, s47, s69
    s_add_u32 s68, s68, 1
    s_cmp_eq_u32 s68, 22
    s_cselect_b32 s68, 0, s68
    buffer_load_dwordx4 v5, s[32:35], s47 offen offset:0 lds
    buffer_load_dwordx4 v6, s[32:35], s47 offen offset:1024 lds
    ds_read_b64_tr_b16 v[12:13], v8 offset:12288
    ds_read_b64_tr_b16 v[14:15], v8 offset:13312
    ds_read_b64_tr_b16 v[16:17], v9 offset:12288
    ds_read_b64_tr_b16 v[18:19], v9 offset:13312
    s_waitcnt vmcnt(14) lgkmcnt(4)
    v_mfma_f32_32x32x16_bf16 v[32:47], v[20:23], v[168:171], v[32:47]
    v_mfma_f32_32x32x16_bf16 v[48:63], v[24:27], v[168:171], v[48:63]
    s_min_u32 s47, s67, s73
    s_lshl_b32 s47, s47, 10
    s_add_u32 s47, s47, s70
    s_add_u32 s67, s67, 1
    s_cmp_eq_u32 s67, 22
    s_cselect_b32 s67, 0, s67
    buffer_load_dwordx4 v[136:139], v104, s[28:31], s47 offen sc1
    buffer_load_dwordx4 v[140:143], v105, s[28:31], s47 offen sc1
    v_mfma_f32_32x32x16_bf16 v[64:79], v[20:23], v[172:175], v[64:79]
    v_mfma_f32_32x32x16_bf16 v[80:95], v[24:27], v[172:175], v[80:95]
    s_add_u32 m0, s66, 10240
    s_lshl_b32 s47, s68, 14
    s_add_u32 s47, s47, s69
    s_add_u32 s68, s68, 1
    s_cmp_eq_u32 s68, 22
    s_cselect_b32 s68, 0, s68
    buffer_load_dwordx4 v5, s[32:35], s47 offen offset:0 lds
    buffer_load_dwordx4 v6, s[32:35], s47 offen offset:1024 lds
    ds_read_b64_tr_b16 v[20:21], v8 offset:14336
    ds_read_b64_tr_b16 v[22:23], v8 offset:15360
    ds_read_b64_tr_b16 v[24:25], v9 offset:14336
    ds_read_b64_tr_b16 v[26:27], v9 offset:15360
    s_waitcnt vmcnt(14) lgkmcnt(4)
    v_mfma_f32_32x32x16_bf16 v[32:47], v[12:15], v[176:179], v[32:47]
    v_mfma_f32_32x32x16_bf16 v[48:63], v[16:19], v[176:179], v[48:63]
    s_min_u32 s47, s67, s73
    s_lshl_b32 s47, s47, 10
    s_add_u32 s47, s47, s70
    s_add_u32 s67, s67, 1
    s_cmp_eq_u32 s67, 22
    s_cselect_b32 s67, 0, s67
    buffer_load_dwordx4 v[144:147], v104, s[28:31], s47 offen sc1
    buffer_load_dwordx4 v[148:151], v105, s[28:31], s47 offen sc1
    v_mfma_f32_32x32x16_bf16 v[64:79], v[12:15], v[180:183], v[64:79]
    v_mfma_f32_32x32x16_bf16 v[80:95], v[16:19], v[180:183], v[80:95]
    s_add_u32 m0, s66, 12288
    s_lshl_b32 s47, s68, 14
    s_add_u32 s47, s47, s69
    s_add_u32 s68, s68, 1
    s_cmp_eq_u32 s68, 22
    s_cselect_b32 s68, 0, s68
    buffer_load_dwordx4 v5, s[32:35], s47 offen offset:0 lds
    buffer_load_dwordx4 v6, s[32:35], s47 offen offset:1024 lds
    ds_read_b64_tr_b16 v[12:13], v8 offset:16384
    ds_read_b64_tr_b16 v[14:15], v8 offset:17408
    ds_read_b64_tr_b16 v[16:17], v9 offset:16384
    ds_read_b64_tr_b16 v[18:19], v9 offset:17408
    s_waitcnt vmcnt(14) lgkmcnt(4)
    v_mfma_f32_32x32x16_bf16 v[32:47], v[20:23], v[184:187], v[32:47]
    v_mfma_f32_32x32x16_bf16 v[48:63], v[24:27], v[184:187], v[48:63]
    s_min_u32 s47, s67, s73
    s_lshl_b32 s47, s47, 10
    s_add_u32 s47, s47, s70
    s_add_u32 s67, s67, 1
    s_cmp_eq_u32 s67, 22
    s_cselect_b32 s67, 0, s67
    buffer_load_dwordx4 v[152:155], v104, s[28:31], s47 offen sc1
    buffer_load_dwordx4 v[156:159], v105, s[28:31], s47 offen sc1
    v_mfma_f32_32x32x16_bf16 v[64:79], v[20:23], v[188:191], v[64:79]
    v_mfma_f32_32x32x16_bf16 v[80:95], v[24:27], v[188:191], v[80:95]
    s_add_u32 m0, s66, 14336
    s_lshl_b32 s47, s68, 14
    s_add_u32 s47, s47, s69
    s_add_u32 s68, s68, 1
    s_cmp_eq_u32 s68, 22
    s_cselect_b32 s68, 0, s68
    buffer_load_dwordx4 v5, s[32:35], s47 offen offset:0 lds
    buffer_load_dwordx4 v6, s[32:35], s47 offen offset:1024 lds
    ds_read_b64_tr_b16 v[20:21], v8 offset:18432
    ds_read_b64_tr_b16 v[22:23], v8 offset:19456
    ds_read_b64_tr_b16 v[24:25], v9 offset:18432
    ds_read_b64_tr_b16 v[26:27], v9 offset:19456
    s_waitcnt vmcnt(14) lgkmcnt(4)
    v_mfma_f32_32x32x16_bf16 v[32:47], v[12:15], v[128:131], v[32:47]
    v_mfma_f32_32x32x16_bf16 v[48:63], v[16:19], v[128:131], v[48:63]
    s_min_u32 s47, s67, s73
    s_lshl_b32 s47, s47, 10
    s_add_u32 s47, s47, s70
    s_add_u32 s67, s67, 1
    s_cmp_eq_u32 s67, 22
    s_cselect_b32 s67, 0, s67
    buffer_load_dwordx4 v[160:163], v104, s[28:31], s47 offen sc1
    buffer_load_dwordx4 v[164:167], v105, s[28:31], s47 offen sc1
    v_mfma_f32_32x32x16_bf16 v[64:79], v[12:15], v[132:135], v[64:79]
    v_mfma_f32_32x32x16_bf16 v[80:95], v[16:19], v[132:135], v[80:95]
    s_add_u32 m0, s66, 16384
    s_lshl_b32 s47, s68, 14
    s_add_u32 s47, s47, s69
    s_add_u32 s68, s68, 1
    s_cmp_eq_u32 s68, 22
    s_cselect_b32 s68, 0, s68
    buffer_load_dwordx4 v5, s[32:35], s47 offen offset:0 lds
    buffer_load_dwordx4 v6, s[32:35], s47 offen offset:1024 lds
    ds_read_b64_tr_b16 v[12:13], v8 offset:20480
    ds_read_b64_tr_b16 v[14:15], v8 offset:21504
    ds_read_b64_tr_b16 v[16:17], v9 offset:20480
    ds_read_b64_tr_b16 v[18:19], v9 offset:21504
    s_waitcnt vmcnt(14) lgkmcnt(4)
    v_mfma_f32_32x32x16_bf16 v[32:47], v[20:23], v[136:139], v[32:47]
    v_mfma_f32_32x32x16_bf16 v[48:63], v[24:27], v[136:139], v[48:63]
    s_min_u32 s47, s67, s73
    s_lshl_b32 s47, s47, 10
    s_add_u32 s47, s47, s70
    s_add_u32 s67, s67, 1
    s_cmp_eq_u32 s67, 22
    s_cselect_b32 s67, 0, s67
    buffer_load_dwordx4 v[168:171], v104, s[28:31], s47 offen sc1
    buffer_load_dwordx4 v[172:175], v105, s[28:31], s47 offen sc1
    v_mfma_f32_32x32x16_bf16 v[64:79], v[20:23], v[140:143], v[64:79]
    v_mfma_f32_32x32x16_bf16 v[80:95], v[24:27], v[140:143], v[80:95]
    s_add_u32 m0, s66, 18432
    s_lshl_b32 s47, s3, 17
    s_lshl_b32 s48, s72, 7
    s_add_u32 s47, s47, s48
    s_add_u32 s47, s47, 0
    buffer_load_dwordx4 v5, s[36:39], s47 offen offset:0 lds
    buffer_load_dwordx4 v6, s[36:39], s47 offen offset:1024 lds
    ds_read_b64_tr_b16 v[20:21], v8 offset:22528
    ds_read_b64_tr_b16 v[22:23], v8 offset:23552
    ds_read_b64_tr_b16 v[24:25], v9 offset:22528
    ds_read_b64_tr_b16 v[26:27], v9 offset:23552
    s_waitcnt vmcnt(14) lgkmcnt(4)
    v_mfma_f32_32x32x16_bf16 v[32:47], v[12:15], v[144:147], v[32:47]
    v_mfma_f32_32x32x16_bf16 v[48:63], v[16:19], v[144:147], v[48:63]
    s_min_u32 s47, s67, s73
    s_lshl_b32 s47, s47, 10
    s_add_u32 s47, s47, s70
    s_add_u32 s67, s67, 1
    s_cmp_eq_u32 s67, 22
    s_cselect_b32 s67, 0, s67
    buffer_load_dwordx4 v[176:179], v104, s[28:31], s47 offen sc1
    buffer_load_dwordx4 v[180:183], v105, s[28:31], s47 offen sc1
    v_mfma_f32_32x32x16_bf16 v[64:79], v[12:15], v[148:151], v[64:79]
    v_mfma_f32_32x32x16_bf16 v[80:95], v[16:19], v[148:151], v[80:95]
    s_add_u32 m0, s66, 20480
    s_lshl_b32 s47, s3, 17
    s_lshl_b32 s48, s72, 7
    s_add_u32 s47, s47, s48
    s_add_u32 s47, s47, 16384
    buffer_load_dwordx4 v5, s[36:39], s47 offen offset:0 lds
    buffer_load_dwordx4 v6, s[36:39], s47 offen offset:1024 lds
    ds_read_b64_tr_b16 v[12:13], v8 offset:24576
    ds_read_b64_tr_b16 v[14:15], v8 offset:25600
    ds_read_b64_tr_b16 v[16:17], v9 offset:24576
    ds_read_b64_tr_b16 v[18:19], v9 offset:25600
    s_waitcnt vmcnt(14) lgkmcnt(4)
    v_mfma_f32_32x32x16_bf16 v[32:47], v[20:23], v[152:155], v[32:47]
    v_mfma_f32_32x32x16_bf16 v[48:63], v[24:27], v[152:155], v[48:63]
    s_min_u32 s47, s67, s73
    s_lshl_b32 s47, s47, 10
    s_add_u32 s47, s47, s70
    s_add_u32 s67, s67, 1
    s_cmp_eq_u32 s67, 22
    s_cselect_b32 s67, 0, s67
    buffer_load_dwordx4 v[184:187], v104, s[28:31], s47 offen sc1
    buffer_load_dwordx4 v[188:191], v105, s[28:31], s47 offen sc1
    v_mfma_f32_32x32x16_bf16 v[64:79], v[20:23], v[156:159], v[64:79]
    v_mfma_f32_32x32x16_bf16 v[80:95], v[24:27], v[156:159], v[80:95]
    s_add_u32 m0, s66, 22528
    s_lshl_b32 s47, s3, 17
    s_lshl_b32 s48, s72, 7
    s_add_u32 s47, s47, s48
    s_add_u32 s47, s47, 32768
    buffer_load_dwordx4 v5, s[36:39], s47 offen offset:0 lds
    buffer_load_dwordx4 v6, s[36:39], s47 offen offset:1024 lds
    ds_read_b64_tr_b16 v[20:21], v8 offset:0
    ds_read_b64_tr_b16 v[22:23], v8 offset:1024
    ds_read_b64_tr_b16 v[24:25], v9 offset:0
    ds_read_b64_tr_b16 v[26:27], v9 offset:1024
    s_waitcnt vmcnt(14) lgkmcnt(4)
    v_mfma_f32_32x32x16_bf16 v[32:47], v[12:15], v[160:163], v[32:47]
    v_mfma_f32_32x32x16_bf16 v[48:63], v[16:19], v[160:163], v[48:63]
    s_min_u32 s47, s67, s73
    s_lshl_b32 s47, s47, 10
    s_add_u32 s47, s47, s70
    s_add_u32 s67, s67, 1
    s_cmp_eq_u32 s67, 22
    s_cselect_b32 s67, 0, s67
    buffer_load_dwordx4 v[128:131], v104, s[28:31], s47 offen sc1
    buffer_load_dwordx4 v[132:135], v105, s[28:31], s47 offen sc1
    v_mfma_f32_32x32x16_bf16 v[64:79], v[12:15], v[164:167], v[64:79]
    v_mfma_f32_32x32x16_bf16 v[80:95], v[16:19], v[164:167], v[80:95]
    s_add_u32 m0, s66, 24576
    s_lshl_b32 s47, s3, 17
    s_lshl_b32 s48, s72, 7
    s_add_u32 s47, s47, s48
    s_add_u32 s47, s47, 49152
    buffer_load_dwordx4 v5, s[36:39], s47 offen offset:0 lds
    buffer_load_dwordx4 v6, s[36:39], s47 offen offset:1024 lds
    ds_read_b64_tr_b16 v[12:13], v8 offset:2048
    ds_read_b64_tr_b16 v[14:15], v8 offset:3072
    ds_read_b64_tr_b16 v[16:17], v9 offset:2048
    ds_read_b64_tr_b16 v[18:19], v9 offset:3072
    s_waitcnt vmcnt(14) lgkmcnt(4)
    v_mfma_f32_32x32x16_bf16 v[32:47], v[20:23], v[168:171], v[32:47]
    v_mfma_f32_32x32x16_bf16 v[48:63], v[24:27], v[168:171], v[48:63]
    s_min_u32 s47, s67, s73
    s_lshl_b32 s47, s47, 10
    s_add_u32 s47, s47, s70
    s_add_u32 s67, s67, 1
    s_cmp_eq_u32 s67, 22
    s_cselect_b32 s67, 0, s67
    buffer_load_dwordx4 v[136:139], v104, s[28:31], s47 offen sc1
    buffer_load_dwordx4 v[140:143], v105, s[28:31], s47 offen sc1
    v_mfma_f32_32x32x16_bf16 v[64:79], v[20:23], v[172:175], v[64:79]
    v_mfma_f32_32x32x16_bf16 v[80:95], v[24:27], v[172:175], v[80:95]
    s_add_u32 m0, s66, 0
    s_lshl_b32 s47, s3, 17
    s_lshl_b32 s48, s72, 7
    s_add_u32 s47, s47, s48
    s_add_u32 s47, s47, 65536
    buffer_load_dwordx4 v5, s[36:39], s47 offen offset:0 lds
    buffer_load_dwordx4 v6, s[36:39], s47 offen offset:1024 lds
    ds_read_b64_tr_b16 v[20:21], v8 offset:4096
    ds_read_b64_tr_b16 v[22:23], v8 offset:5120
    ds_read_b64_tr_b16 v[24:25], v9 offset:4096
    ds_read_b64_tr_b16 v[26:27], v9 offset:5120
    s_waitcnt vmcnt(14) lgkmcnt(4)
    v_mfma_f32_32x32x16_bf16 v[32:47], v[12:15], v[176:179], v[32:47]
    v_mfma_f32_32x32x16_bf16 v[48:63], v[16:19], v[176:179], v[48:63]
    s_min_u32 s47, s67, s73
    s_lshl_b32 s47, s47, 10
    s_add_u32 s47, s47, s70
    s_add_u32 s67, s67, 1
    s_cmp_eq_u32 s67, 22
    s_cselect_b32 s67, 0, s67
    buffer_load_dwordx4 v[144:147], v104, s[28:31], s47 offen sc1
    buffer_load_dwordx4 v[148:151], v105, s[28:31], s47 offen sc1
    v_mfma_f32_32x32x16_bf16 v[64:79], v[12:15], v[180:183], v[64:79]
    v_mfma_f32_32x32x16_bf16 v[80:95], v[16:19], v[180:183], v[80:95]
    s_add_u32 m0, s66, 2048
    s_lshl_b32 s47, s3, 17
    s_lshl_b32 s48, s72, 7
    s_add_u32 s47, s47, s48
    s_add_u32 s47, s47, 81920
    buffer_load_dwordx4 v5, s[36:39], s47 offen offset:0 lds
    buffer_load_dwordx4 v6, s[36:39], s47 offen offset:1024 lds
    ds_read_b64_tr_b16 v[12:13], v8 offset:6144
    ds_read_b64_tr_b16 v[14:15], v8 offset:7168
    ds_read_b64_tr_b16 v[16:17], v9 offset:6144
    ds_read_b64_tr_b16 v[18:19], v9 offset:7168
    s_waitcnt vmcnt(14) lgkmcnt(4)
    v_mfma_f32_32x32x16_bf16 v[32:47], v[20:23], v[184:187], v[32:47]
    v_mfma_f32_32x32x16_bf16 v[48:63], v[24:27], v[184:187], v[48:63]
    s_min_u32 s47, s67, s73
    s_lshl_b32 s47, s47, 10
    s_add_u32 s47, s47, s70
    s_add_u32 s67, s67, 1
    s_cmp_eq_u32 s67, 22
    s_cselect_b32 s67, 0, s67
    buffer_load_dwordx4 v[152:155], v104, s[28:31], s47 offen sc1
    buffer_load_dwordx4 v[156:159], v105, s[28:31], s47 offen sc1
    v_mfma_f32_32x32x16_bf16 v[64:79], v[20:23], v[188:191], v[64:79]
    v_mfma_f32_32x32x16_bf16 v[80:95], v[24:27], v[188:191], v[80:95]
    s_add_u32 m0, s66, 4096
    s_lshl_b32 s47, s3, 17
    s_lshl_b32 s48, s72, 7
    s_add_u32 s47, s47, s48
    s_add_u32 s47, s47, 98304
    buffer_load_dwordx4 v5, s[36:39], s47 offen offset:0 lds
    buffer_load_dwordx4 v6, s[36:39], s47 offen offset:1024 lds
    ds_read_b64_tr_b16 v[20:21], v8 offset:8192
    ds_read_b64_tr_b16 v[22:23], v8 offset:9216
    ds_read_b64_tr_b16 v[24:25], v9 offset:8192
    ds_read_b64_tr_b16 v[26:27], v9 offset:9216
    s_waitcnt vmcnt(14) lgkmcnt(4)
    v_mfma_f32_32x32x16_bf16 v[32:47], v[12:15], v[128:131], v[32:47]
    v_mfma_f32_32x32x16_bf16 v[48:63], v[16:19], v[128:131], v[48:63]
    s_min_u32 s47, s67, s73
    s_lshl_b32 s47, s47, 10
    s_add_u32 s47, s47, s70
    s_add_u32 s67, s67, 1
    s_cmp_eq_u32 s67, 22
    s_cselect_b32 s67, 0, s67
    buffer_load_dwordx4 v[160:163], v104, s[28:31], s47 offen sc1
    buffer_load_dwordx4 v[164:167], v105, s[28:31], s47 offen sc1
    v_mfma_f32_32x32x16_bf16 v[64:79], v[12:15], v[132:135], v[64:79]
    v_mfma_f32_32x32x16_bf16 v[80:95], v[16:19], v[132:135], v[80:95]
    s_add_u32 m0, s66, 6144
    s_lshl_b32 s47, s3, 17
    s_lshl_b32 s48, s72, 7
    s_add_u32 s47, s47, s48
    s_add_u32 s47, s47, 114688
    buffer_load_dwordx4 v5, s[36:39], s47 offen offset:0 lds
    buffer_load_dwordx4 v6, s[36:39], s47 offen offset:1024 lds
    ds_read_b64_tr_b16 v[12:13], v8 offset:10240
    ds_read_b64_tr_b16 v[14:15], v8 offset:11264
    ds_read_b64_tr_b16 v[16:17], v9 offset:10240
    ds_read_b64_tr_b16 v[18:19], v9 offset:11264
    s_waitcnt vmcnt(14) lgkmcnt(4)
    v_mfma_f32_32x32x16_bf16 v[32:47], v[20:23], v[136:139], v[32:47]
    v_mfma_f32_32x32x16_bf16 v[48:63], v[24:27], v[136:139], v[48:63]
    s_min_u32 s47, s67, s73
    s_lshl_b32 s47, s47, 10
    s_add_u32 s47, s47, s70
    s_add_u32 s67, s67, 1
    s_cmp_eq_u32 s67, 22
    s_cselect_b32 s67, 0, s67
    buffer_load_dwordx4 v[168:171], v104, s[28:31], s47 offen sc1
    buffer_load_dwordx4 v[172:175], v105, s[28:31], s47 offen sc1
    v_mfma_f32_32x32x16_bf16 v[64:79], v[20:23], v[140:143], v[64:79]
    v_mfma_f32_32x32x16_bf16 v[80:95], v[24:27], v[140:143], v[80:95]
    ds_read_b64_tr_b16 v[20:21], v8 offset:12288
    ds_read_b64_tr_b16 v[22:23], v8 offset:13312
    ds_read_b64_tr_b16 v[24:25], v9 offset:12288
    ds_read_b64_tr_b16 v[26:27], v9 offset:13312
    s_waitcnt vmcnt(12) lgkmcnt(4)
    v_mfma_f32_32x32x16_bf16 v[32:47], v[12:15], v[144:147], v[32:47]
    v_mfma_f32_32x32x16_bf16 v[48:63], v[16:19], v[144:147], v[48:63]
    v_mfma_f32_32x32x16_bf16 v[64:79], v[12:15], v[148:151], v[64:79]
    v_mfma_f32_32x32x16_bf16 v[80:95], v[16:19], v[148:151], v[80:95]
    ds_read_b64_tr_b16 v[12:13], v8 offset:14336
    ds_read_b64_tr_b16 v[14:15], v8 offset:15360
    ds_read_b64_tr_b16 v[16:17], v9 offset:14336
    ds_read_b64_tr_b16 v[18:19], v9 offset:15360
    s_waitcnt vmcnt(8) lgkmcnt(4)
    v_mfma_f32_32x32x16_bf16 v[32:47], v[20:23], v[152:155], v[32:47]
    v_mfma_f32_32x32x16_bf16 v[48:63], v[24:27], v[152:155], v[48:63]
    v_mfma_f32_32x32x16_bf16 v[64:79], v[20:23], v[156:159], v[64:79]
    v_mfma_f32_32x32x16_bf16 v[80:95], v[24:27], v[156:159], v[80:95]
    ds_read_b64_tr_b16 v[20:21], v8 offset:16384
    ds_read_b64_tr_b16 v[22:23], v8 offset:17408
    ds_read_b64_tr_b16 v[24:25], v9 offset:16384
    ds_read_b64_tr_b16 v[26:27], v9 offset:17408
    s_waitcnt vmcnt(4) lgkmcnt(4)
    v_mfma_f32_32x32x16_bf16 v[32:47], v[12:15], v[160:163], v[32:47]
    v_mfma_f32_32x32x16_bf16 v[48:63], v[16:19], v[160:163], v[48:63]
    v_mfma_f32_32x32x16_bf16 v[64:79], v[12:15], v[164:167], v[64:79]
    v_mfma_f32_32x32x16_bf16 v[80:95], v[16:19], v[164:167], v[80:95]
    ds_read_b64_tr_b16 v[192:193], v8 offset:18432
    ds_read_b64_tr_b16 v[194:195], v8 offset:19456
    ds_read_b64_tr_b16 v[196:197], v9 offset:18432
    ds_read_b64_tr_b16 v[198:199], v9 offset:19456
    s_waitcnt vmcnt(0) lgkmcnt(4)
    v_mfma_f32_32x32x16_bf16 v[32:47], v[20:23], v[168:171], v[32:47]
    v_mfma_f32_32x32x16_bf16 v[48:63], v[24:27], v[168:171], v[48:63]
    v_mfma_f32_32x32x16_bf16 v[64:79], v[20:23], v[172:175], v[64:79]
    v_mfma_f32_32x32x16_bf16 v[80:95], v[24:27], v[172:175], v[80:95]
    s_setprio 3
    s_lshl_b32 s70, s71, 1
    s_lshr_b32 s47, s3, 1
    s_add_u32 s70, s70, s47
    s_lshl_b32 s70, s70, 15
    s_lshl_b32 s47, s72, 1
    s_and_b32 s48, s3, 1
    s_add_u32 s47, s47, s48
    s_lshl_b32 s47, s47, 6
    s_add_u32 s70, s70, s47
    s_lshl_b32 s69, s71, 16
    s_lshl_b32 s47, s3, 13
    s_add_u32 s69, s69, s47
    s_add_u32 s69, s69, 8388608
    s_add_u32 s68, s69, 4096
    buffer_load_dwordx4 v[96:99], v110, s[24:27], s70 offen offset:0
    buffer_load_dwordx4 v[100:103], v110, s[24:27], s70 offen offset:16
    ds_read_b64_tr_b16 v[200:201], v8 offset:20480
    ds_read_b64_tr_b16 v[202:203], v8 offset:21504
    ds_read_b64_tr_b16 v[204:205], v9 offset:20480
    ds_read_b64_tr_b16 v[206:207], v9 offset:21504
    ds_read_b64_tr_b16 v[208:209], v8 offset:22528
    ds_read_b64_tr_b16 v[210:211], v8 offset:23552
    ds_read_b64_tr_b16 v[212:213], v9 offset:22528
    ds_read_b64_tr_b16 v[214:215], v9 offset:23552
    ds_read_b64_tr_b16 v[216:217], v8 offset:24576
    ds_read_b64_tr_b16 v[218:219], v8 offset:25600
    ds_read_b64_tr_b16 v[220:221], v9 offset:24576
    ds_read_b64_tr_b16 v[222:223], v9 offset:25600
    ds_read_b64_tr_b16 v[224:225], v8 offset:0
    ds_read_b64_tr_b16 v[226:227], v8 offset:1024
    ds_read_b64_tr_b16 v[228:229], v9 offset:0
    ds_read_b64_tr_b16 v[230:231], v9 offset:1024
    ds_read_b64_tr_b16 v[232:233], v8 offset:2048
    ds_read_b64_tr_b16 v[234:235], v8 offset:3072
    ds_read_b64_tr_b16 v[236:237], v9 offset:2048
    ds_read_b64_tr_b16 v[238:239], v9 offset:3072
    ds_read_b64_tr_b16 v[240:241], v8 offset:4096
    ds_read_b64_tr_b16 v[242:243], v8 offset:5120
    ds_read_b64_tr_b16 v[244:245], v9 offset:4096
    ds_read_b64_tr_b16 v[246:247], v9 offset:5120
    ds_read_b64_tr_b16 v[248:249], v8 offset:6144
    ds_read_b64_tr_b16 v[250:251], v8 offset:7168
    ds_read_b64_tr_b16 v[252:253], v9 offset:6144
    ds_read_b64_tr_b16 v[254:255], v9 offset:7168
    s_waitcnt vmcnt(0)
    v_lshlrev_b32 v2, 16, v96
    v_and_b32 v3, 0xffff0000, v96
    v_add_f32 v32, v32, v2
    v_add_f32 v33, v33, v3
    v_lshlrev_b32 v2, 16, v97
    v_and_b32 v3, 0xffff0000, v97
    v_add_f32 v34, v34, v2
    v_add_f32 v35, v35, v3
    v_lshlrev_b32 v2, 16, v98
    v_and_b32 v3, 0xffff0000, v98
    v_add_f32 v36, v36, v2
    v_add_f32 v37, v37, v3
    v_lshlrev_b32 v2, 16, v99
    v_and_b32 v3, 0xffff0000, v99
    v_add_f32 v38, v38, v2
    v_add_f32 v39, v39, v3
    v_lshlrev_b32 v2, 16, v100
    v_and_b32 v3, 0xffff0000, v100
    v_add_f32 v40, v40, v2
    v_add_f32 v41, v41, v3
    v_lshlrev_b32 v2, 16, v101
    v_and_b32 v3, 0xffff0000, v101
    v_add_f32 v42, v42, v2
    v_add_f32 v43, v43, v3
    v_lshlrev_b32 v2, 16, v102
    v_and_b32 v3, 0xffff0000, v102
    v_add_f32 v44, v44, v2
    v_add_f32 v45, v45, v3
    v_lshlrev_b32 v2, 16, v103
    v_and_b32 v3, 0xffff0000, v103
    v_add_f32 v46, v46, v2
    v_add_f32 v47, v47, v3
    s_xor_b32 s47, s3, 1
    s_mul_i32 s47, s47, 12288
    v_add_u32 v112, s47, v11
    s_xor_b32 s47, s3, 2
    s_mul_i32 s47, s47, 12288
    v_add_u32 v113, s47, v11
    s_xor_b32 s47, s3, 3
    s_mul_i32 s47, s47, 12288
    v_add_u32 v114, s47, v11
    s_mul_i32 s47, s3, 12288
    v_add_u32 v111, s47, v11
    s_waitcnt lgkmcnt(0)
    s_barrier
    s_setprio 3
    s_mov_b32 s51, 32768
fb_o:
    buffer_load_dword v4, v109, s[28:31], 0 offen sc1
fb_o_chk:
    s_waitcnt vmcnt(0)
    v_cmp_ne_u32 vcc, 1, v4
    s_cbranch_vccz fb_o_ok
    s_sub_u32 s51, s51, 1
    s_cmp_lg_u32 s51, 0
    s_cbranch_scc1 fb_o
fb_o_ok:
    buffer_load_dwordx4 v[128:131], v106, s[28:31], s69 offen offset:0 sc1
    buffer_load_dwordx4 v[132:135], v107, s[28:31], s69 offen offset:0 sc1
    buffer_load_dwordx4 v[136:139], v106, s[28:31], s69 offen offset:1024 sc1
    buffer_load_dwordx4 v[140:143], v107, s[28:31], s69 offen offset:1024 sc1
    buffer_load_dwordx4 v[144:147], v106, s[28:31], s69 offen offset:2048 sc1
    buffer_load_dwordx4 v[148:151], v107, s[28:31], s69 offen offset:2048 sc1
    buffer_load_dwordx4 v[152:155], v106, s[28:31], s69 offen offset:3072 sc1
    buffer_load_dwordx4 v[156:159], v107, s[28:31], s69 offen offset:3072 sc1
    buffer_load_dwordx4 v[160:163], v106, s[28:31], s68 offen offset:0 sc1
    buffer_load_dwordx4 v[164:167], v107, s[28:31], s68 offen offset:0 sc1
    buffer_load_dwordx4 v[168:171], v106, s[28:31], s68 offen offset:1024 sc1
    buffer_load_dwordx4 v[172:175], v107, s[28:31], s68 offen offset:1024 sc1
    buffer_load_dwordx4 v[176:179], v106, s[28:31], s68 offen offset:2048 sc1
    buffer_load_dwordx4 v[180:183], v107, s[28:31], s68 offen offset:2048 sc1
    buffer_load_dwordx4 v[184:187], v106, s[28:31], s68 offen offset:3072 sc1
    buffer_load_dwordx4 v[188:191], v107, s[28:31], s68 offen offset:3072 sc1
    s_waitcnt vmcnt(14)
    v_mfma_f32_32x32x16_bf16 v[80:95], v[196:199], v[132:135], v[80:95]
    v_mfma_f32_32x32x16_bf16 v[64:79], v[192:195], v[132:135], v[64:79]
    v_mfma_f32_32x32x16_bf16 v[48:63], v[196:199], v[128:131], v[48:63]
    v_mfma_f32_32x32x16_bf16 v[32:47], v[192:195], v[128:131], v[32:47]
    s_waitcnt vmcnt(12)
    v_mfma_f32_32x32x16_bf16 v[80:95], v[204:207], v[140:143], v[80:95]
    v_mfma_f32_32x32x16_bf16 v[64:79], v[200:203], v[140:143], v[64:79]
    v_mfma_f32_32x32x16_bf16 v[48:63], v[204:207], v[136:139], v[48:63]
    v_mfma_f32_32x32x16_bf16 v[32:47], v[200:203], v[136:139], v[32:47]
    s_waitcnt vmcnt(10)
    v_mfma_f32_32x32x16_bf16 v[80:95], v[212:215], v[148:151], v[80:95]
    v_mfma_f32_32x32x16_bf16 v[64:79], v[208:211], v[148:151], v[64:79]
    v_mfma_f32_32x32x16_bf16 v[48:63], v[212:215], v[144:147], v[48:63]
    v_mfma_f32_32x32x16_bf16 v[32:47], v[208:211], v[144:147], v[32:47]
    s_waitcnt vmcnt(8)
    v_mfma_f32_32x32x16_bf16 v[80:95], v[220:223], v[156:159], v[80:95]
    v_mfma_f32_32x32x16_bf16 v[64:79], v[216:219], v[156:159], v[64:79]
    v_mfma_f32_32x32x16_bf16 v[48:63], v[220:223], v[152:155], v[48:63]
    v_mfma_f32_32x32x16_bf16 v[32:47], v[216:219], v[152:155], v[32:47]
    s_waitcnt vmcnt(6)
    v_mfma_f32_32x32x16_bf16 v[80:95], v[228:231], v[164:167], v[80:95]
    v_mfma_f32_32x32x16_bf16 v[64:79], v[224:227], v[164:167], v[64:79]
    v_mfma_f32_32x32x16_bf16 v[48:63], v[228:231], v[160:163], v[48:63]
    v_mfma_f32_32x32x16_bf16 v[32:47], v[224:227], v[160:163], v[32:47]
    s_waitcnt vmcnt(4)
    v_mfma_f32_32x32x16_bf16 v[80:95], v[236:239], v[172:175], v[80:95]
    v_mfma_f32_32x32x16_bf16 v[64:79], v[232:235], v[172:175], v[64:79]
    v_mfma_f32_32x32x16_bf16 v[48:63], v[236:239], v[168:171], v[48:63]
    v_mfma_f32_32x32x16_bf16 v[32:47], v[232:235], v[168:171], v[32:47]
    s_waitcnt vmcnt(2)
    v_mfma_f32_32x32x16_bf16 v[80:95], v[244:247], v[180:183], v[80:95]
    v_mfma_f32_32x32x16_bf16 v[64:79], v[240:243], v[180:183], v[64:79]
    v_mfma_f32_32x32x16_bf16 v[48:63], v[244:247], v[176:179], v[48:63]
    v_mfma_f32_32x32x16_bf16 v[32:47], v[240:243], v[176:179], v[32:47]
    s_waitcnt vmcnt(0)
    v_mfma_f32_32x32x16_bf16 v[80:95], v[252:255], v[188:191], v[80:95]
    v_mfma_f32_32x32x16_bf16 v[64:79], v[248:251], v[188:191], v[64:79]
    v_mfma_f32_32x32x16_bf16 v[48:63], v[252:255], v[184:187], v[48:63]
    v_mfma_f32_32x32x16_bf16 v[32:47], v[248:251], v[184:187], v[32:47]
    s_nop 8
    ds_write_b128 v114, v[80:83] offset:8192
    ds_write_b128 v114, v[84:87] offset:9216
    ds_write_b128 v114, v[88:91] offset:10240
    ds_write_b128 v114, v[92:95] offset:11264
    ds_write_b128 v113, v[64:67] offset:4096
    ds_write_b128 v113, v[68:71] offset:5120
    ds_write_b128 v113, v[72:75] offset:6144
    ds_write_b128 v113, v[76:79] offset:7168
    ds_write_b128 v112, v[48:51] offset:0
    ds_write_b128 v112, v[52:55] offset:1024
    ds_write_b128 v112, v[56:59] offset:2048
    ds_write_b128 v112, v[60:63] offset:3072
    s_waitcnt lgkmcnt(0)
    s_barrier
    ds_read_b128 v[48:51], v111 offset:0
    ds_read_b128 v[52:55], v111 offset:1024
    ds_read_b128 v[56:59], v111 offset:2048
    ds_read_b128 v[60:63], v111 offset:3072
    ds_read_b128 v[64:67], v111 offset:4096
    ds_read_b128 v[68:71], v111 offset:5120
    ds_read_b128 v[72:75], v111 offset:6144
    ds_read_b128 v[76:79], v111 offset:7168
    ds_read_b128 v[80:83], v111 offset:8192
    ds_read_b128 v[84:87], v111 offset:9216
    ds_read_b128 v[88:91], v111 offset:10240
    ds_read_b128 v[92:95], v111 offset:11264
    s_waitcnt lgkmcnt(8)
    v_add_f32 v32, v32, v48
    v_add_f32 v33, v33, v49
    v_add_f32 v34, v34, v50
    v_add_f32 v35, v35, v51
    v_add_f32 v36, v36, v52
    v_add_f32 v37, v37, v53
    v_add_f32 v38, v38, v54
    v_add_f32 v39, v39, v55
    v_add_f32 v40, v40, v56
    v_add_f32 v41, v41, v57
    v_add_f32 v42, v42, v58
    v_add_f32 v43, v43, v59
    v_add_f32 v44, v44, v60
    v_add_f32 v45, v45, v61
    v_add_f32 v46, v46, v62
    v_add_f32 v47, v47, v63
    s_waitcnt lgkmcnt(4)
    v_add_f32 v32, v32, v64
    v_add_f32 v33, v33, v65
    v_add_f32 v34, v34, v66
    v_add_f32 v35, v35, v67
    v_add_f32 v36, v36, v68
    v_add_f32 v37, v37, v69
    v_add_f32 v38, v38, v70
    v_add_f32 v39, v39, v71
    v_add_f32 v40, v40, v72
    v_add_f32 v41, v41, v73
    v_add_f32 v42, v42, v74
    v_add_f32 v43, v43, v75
    v_add_f32 v44, v44, v76
    v_add_f32 v45, v45, v77
    v_add_f32 v46, v46, v78
    v_add_f32 v47, v47, v79
    s_waitcnt lgkmcnt(0)
    v_add_f32 v32, v32, v80
    v_add_f32 v33, v33, v81
    v_add_f32 v34, v34, v82
    v_add_f32 v35, v35, v83
    v_add_f32 v36, v36, v84
    v_add_f32 v37, v37, v85
    v_add_f32 v38, v38, v86
    v_add_f32 v39, v39, v87
    v_add_f32 v40, v40, v88
    v_add_f32 v41, v41, v89
    v_add_f32 v42, v42, v90
    v_add_f32 v43, v43, v91
    v_add_f32 v44, v44, v92
    v_add_f32 v45, v45, v93
    v_add_f32 v46, v46, v94
    v_add_f32 v47, v47, v95
    v_cvt_pk_bf16_f32 v96, v32, v33
    v_cvt_pk_bf16_f32 v97, v34, v35
    v_cvt_pk_bf16_f32 v98, v36, v37
    v_cvt_pk_bf16_f32 v99, v38, v39
    v_cvt_pk_bf16_f32 v100, v40, v41
    v_cvt_pk_bf16_f32 v101, v42, v43
    v_cvt_pk_bf16_f32 v102, v44, v45
    v_cvt_pk_bf16_f32 v103, v46, v47
    buffer_store_dwordx4 v[96:99], v110, s[40:43], s70 offen offset:0
    buffer_store_dwordx4 v[100:103], v110, s[40:43], s70 offen offset:16
fz_exit:
    s_endpgm
.section .rodata,"a"
.p2align 6
.amdhsa_kernel parallel_sum__softmax_full_mha__glu_gated_reglu__prompt_kernel
  .amdhsa_next_free_vgpr 256
  .amdhsa_next_free_sgpr 100
  .amdhsa_accum_offset 256
  .amdhsa_group_segment_fixed_size 0
  .amdhsa_kernarg_size 80
  .amdhsa_user_sgpr_count 2
  .amdhsa_user_sgpr_kernarg_segment_ptr 1
  .amdhsa_system_sgpr_workgroup_id_x 1
  .amdhsa_float_denorm_mode_32 3
  .amdhsa_ieee_mode 0
.end_amdhsa_kernel
```
